```python
import torch

def _softmax(x, axis=-1):
    return torch.softmax(x, dim=axis)
def _gelu(x):
    return torch.nn.functional.gelu(x, approximate="tanh")
def _silu(x):
    return torch.nn.functional.silu(x)
def _sigmoid(x):
    return torch.sigmoid(x)
def _layernorm(x, axis=-1, eps=1e-5):
    m = x.mean(dim=axis, keepdim=True)
    v = x.var(dim=axis, keepdim=True, unbiased=False)
    return (x - m) / torch.sqrt(v + eps)
def _scatter_add(tgt, idx, src, axis=0):
    return tgt.clone().index_add_(axis, idx, src)
def _segment_sum(src, seg, n):
    out = torch.zeros((n,) + src.shape[1:], dtype=src.dtype)
    return out.index_add_(0, seg, src)
def _pad(x, pw):
    flat = tuple(v for pair in reversed(pw) for v in pair)
    return torch.nn.functional.pad(x, flat)

kernel_name = 'gather_scatter__molecular_angular_gemnet__graph'

def setup_inputs():

    _w = (lambda a: (lambda t: t.to(torch.bfloat16) if t.is_floating_point() else t)(torch.as_tensor(a)))
    N, deg, De, L = 10000, 16, 4, 1
    E = N * deg
    T = E * deg
    NR = 8
    dist = torch.rand(E).to(float)
    angle = (torch.rand(T) * torch.pi).to(float)
    centers = torch.linspace(0.0, 1.0, NR).to(float)
    ang_freq = torch.arange(1, L + 1).to(float)
    return {
        "m": _w((lambda *s: torch.randn(*s, dtype=torch.bfloat16) * 0.05)(E, De)),
        "idx_in": _w((lambda lo, hi, *s: torch.randint(lo, hi, s))(0, E, T).to(torch.int64)),
        "idx_out": _w((lambda lo, hi, *s: torch.randint(lo, hi, s))(0, E, T).to(torch.int64)),
        "dist": _w(dist),
        "angle": _w(angle),
        "centers": _w(centers),
        "ang_freq": _w(ang_freq),
        "w_rbf": _w((lambda *s: torch.randn(*s, dtype=torch.bfloat16) * 0.4)(NR, De)),
        "w_sbf": _w((lambda *s: torch.randn(*s, dtype=torch.bfloat16) * 0.4)(NR * L, De)),
        "w_down": _w((lambda *s: torch.randn(*s, dtype=torch.bfloat16) * 0.4)(De, De)),
        "w_up": _w((lambda *s: torch.randn(*s, dtype=torch.bfloat16) * 0.4)(De, De)),
    }

def reference(m, idx_in, idx_out, dist, angle, centers, ang_freq, w_rbf, w_sbf, w_down, w_up):
    E, De = m.shape[0], m.shape[1]
    NR = centers.shape[0]
    L = ang_freq.shape[0]
    rbf = torch.exp(-10.0 * (dist[:, None] - centers[None, :]) ** 2)
    cbf = torch.cos(ang_freq[None, :] * angle[:, None])
    rbf_t = rbf[idx_out]
    sbf = torch.reshape(rbf_t[:, :, None] * cbf[:, None, :], (-1, NR * L))
    x = (m[idx_in] @ w_down) * (sbf @ w_sbf)
    agg = _segment_sum(x, idx_out, E)
    return m + (agg @ w_up) * (rbf @ w_rbf)
```

```asm
; @launch grid=(250,1,1) block=(1024,1,1) lds=156752
.amdgcn_target "amdgcn-amd-amdhsa--gfx950"
.text
.globl gather_scatter__molecular_angular_gemnet__graph_kernel
.p2align 8
.type gather_scatter__molecular_angular_gemnet__graph_kernel,@function
gather_scatter__molecular_angular_gemnet__graph_kernel:
  s_cmp_ge_u32 s2, 250
  s_cbranch_scc1 L_end
  s_load_dwordx2 s[4:5], s[0:1], 8
  s_load_dwordx2 s[8:9], s[0:1], 16
  s_load_dwordx2 s[16:17], s[0:1], 32
  s_load_dwordx2 s[36:37], s[0:1], 48
  s_load_dwordx2 s[12:13], s[0:1], 104
  s_load_dwordx2 s[44:45], s[0:1], 0
  s_load_dwordx2 s[48:49], s[0:1], 24
  s_load_dwordx2 s[52:53], s[0:1], 96
  v_lshlrev_b32 v1, 4, v0
  v_lshlrev_b32 v2, 3, v0
  v_lshlrev_b32 v3, 2, v0
  v_mov_b32 v90, 1
  v_mov_b32 v70, 0
  s_mul_i32 s20, s2, 40960
  s_add_u32 s21, s20, 16384
  s_add_u32 s22, s20, 32768
  s_mul_i32 s23, s2, 20480
  s_add_u32 s24, s23, 8192
  s_add_u32 s25, s23, 16384
  s_mov_b32 s6, 10240000
  s_mov_b32 s7, 0x20000
  s_mov_b32 s10, 10240000
  s_mov_b32 s11, 0x20000
  s_mov_b32 s18, 5120000
  s_mov_b32 s19, 0x20000
  s_mov_b32 s14, 268435456
  s_mov_b32 s15, 0x20000
  s_mov_b32 s46, 1280000
  s_mov_b32 s47, 0x20000
  s_mov_b32 s50, 320000
  s_mov_b32 s51, 0x20000
  s_mov_b32 s54, 256
  s_mov_b32 s55, 0x20000
  s_mov_b32 s27, 4294966656
  s_mov_b32 s28, 0x3e22f900
  s_mov_b32 s29, 0x36036e4e
  s_and_b32 s40, s2, 7
  s_lshr_b32 s41, s2, 3
  s_mul_i32 s42, s40, 31
  s_min_u32 s43, s40, 2
  s_add_u32 s3, s42, s43
  s_add_u32 s3, s3, s41
  s_mul_i32 s31, s3, 640
  v_add_u32 v92, s31, v0
  v_lshlrev_b32 v93, 1, v92
  v_lshlrev_b32 v92, 3, v92
  v_cmp_gt_u32 vcc, 0x100, v0
  s_and_saveexec_b64 s[32:33], vcc
  ds_write_b32 v3, v70 offset:0
  s_mov_b64 exec, s[32:33]
  v_lshrrev_b32 v91, 6, v0
  s_waitcnt lgkmcnt(0)
  v_readfirstlane_b32 s30, v91
  s_lshl_b32 s38, s2, 4
  s_or_b32 s38, s38, s30
  s_cmp_lg_u32 s38, 0
  s_cbranch_scc1 L_notag
  s_memrealtime s[38:39]
  s_waitcnt lgkmcnt(0)
  s_or_b32 s38, s38, 1
  v_mov_b32 v104, s38
  v_mov_b32 v105, s39
  s_mov_b64 exec, 1
  buffer_store_dwordx2 v[104:105], v70, s[52:55], 0 offen sc1
  s_mov_b64 exec, -1
L_notag:
  buffer_load_dwordx4 v[4:7], v1, s[8:11], s20 offen nt
  buffer_load_dwordx4 v[8:11], v1, s[8:11], s21 offen nt
  buffer_load_dwordx2 v[12:13], v2, s[8:11], s22 offen nt
  s_load_dword s26, s[36:37], 0
  s_barrier
  buffer_load_dwordx4 v[14:17], v1, s[4:7], s20 offen nt
  buffer_load_dwordx4 v[18:21], v1, s[4:7], s21 offen nt
  buffer_load_dwordx2 v[22:23], v2, s[4:7], s22 offen nt
  buffer_load_dwordx2 v[24:25], v2, s[16:19], s23 offen nt
  buffer_load_dwordx2 v[26:27], v2, s[16:19], s24 offen nt
  buffer_load_dword v28, v3, s[16:19], s25 offen nt
  s_waitcnt lgkmcnt(0)
  s_lshl_b32 s26, s26, 16
  s_waitcnt vmcnt(8)
  v_lshrrev_b32 v60, 7, v4
  v_lshrrev_b32 v61, 7, v5
  v_lshrrev_b32 v62, 7, v6
  v_lshrrev_b32 v63, 7, v7
  v_mul_u32_u24 v60, 0xcccd, v60
  v_mul_u32_u24 v61, 0xcccd, v61
  v_mul_u32_u24 v62, 0xcccd, v62
  v_mul_u32_u24 v63, 0xcccd, v63
  v_lshrrev_b32 v60, 18, v60
  v_lshrrev_b32 v61, 18, v61
  v_lshrrev_b32 v62, 18, v62
  v_lshrrev_b32 v63, 18, v63
  v_lshlrev_b32 v30, 2, v60
  v_lshlrev_b32 v31, 2, v61
  v_lshlrev_b32 v32, 2, v62
  v_lshlrev_b32 v33, 2, v63
  ds_add_rtn_u32 v50, v30, v90 offset:0
  ds_add_rtn_u32 v51, v31, v90 offset:0
  ds_add_rtn_u32 v52, v32, v90 offset:0
  ds_add_rtn_u32 v53, v33, v90 offset:0
  v_mad_i32_i24 v40, v60, s27, v4
  v_mad_i32_i24 v41, v61, s27, v5
  v_mad_i32_i24 v42, v62, s27, v6
  v_mad_i32_i24 v43, v63, s27, v7
  s_waitcnt vmcnt(7)
  v_lshrrev_b32 v64, 7, v8
  v_lshrrev_b32 v65, 7, v9
  v_lshrrev_b32 v66, 7, v10
  v_lshrrev_b32 v67, 7, v11
  v_mul_u32_u24 v64, 0xcccd, v64
  v_mul_u32_u24 v65, 0xcccd, v65
  v_mul_u32_u24 v66, 0xcccd, v66
  v_mul_u32_u24 v67, 0xcccd, v67
  v_lshrrev_b32 v64, 18, v64
  v_lshrrev_b32 v65, 18, v65
  v_lshrrev_b32 v66, 18, v66
  v_lshrrev_b32 v67, 18, v67
  v_lshlrev_b32 v34, 2, v64
  v_lshlrev_b32 v35, 2, v65
  v_lshlrev_b32 v36, 2, v66
  v_lshlrev_b32 v37, 2, v67
  ds_add_rtn_u32 v54, v34, v90 offset:0
  ds_add_rtn_u32 v55, v35, v90 offset:0
  ds_add_rtn_u32 v56, v36, v90 offset:0
  ds_add_rtn_u32 v57, v37, v90 offset:0
  v_mad_i32_i24 v44, v64, s27, v8
  v_mad_i32_i24 v45, v65, s27, v9
  v_mad_i32_i24 v46, v66, s27, v10
  v_mad_i32_i24 v47, v67, s27, v11
  s_waitcnt vmcnt(6)
  v_lshrrev_b32 v68, 7, v12
  v_lshrrev_b32 v69, 7, v13
  v_mul_u32_u24 v68, 0xcccd, v68
  v_mul_u32_u24 v69, 0xcccd, v69
  v_lshrrev_b32 v68, 18, v68
  v_lshrrev_b32 v69, 18, v69
  v_lshlrev_b32 v38, 2, v68
  v_lshlrev_b32 v39, 2, v69
  ds_add_rtn_u32 v58, v38, v90 offset:0
  ds_add_rtn_u32 v59, v39, v90 offset:0
  v_mad_i32_i24 v48, v68, s27, v12
  v_mad_i32_i24 v49, v69, s27, v13
  s_waitcnt lgkmcnt(0)
  s_barrier
  v_and_b32 v71, 63, v0
  v_lshlrev_b32 v72, 4, v71
  ds_read_b128 v[74:77], v72 offset:0
  s_waitcnt lgkmcnt(0)
  v_add_u32 v79, v74, v75
  v_add_u32 v80, v79, v76
  v_add_u32 v81, v80, v77
  v_mov_b32 v82, v81
  s_nop 1
  v_add_u32_dpp v82, v82, v82 row_shr:1 row_mask:0xf bank_mask:0xf bound_ctrl:0
  s_nop 1
  v_add_u32_dpp v82, v82, v82 row_shr:2 row_mask:0xf bank_mask:0xf bound_ctrl:0
  s_nop 1
  v_add_u32_dpp v82, v82, v82 row_shr:4 row_mask:0xf bank_mask:0xf bound_ctrl:0
  s_nop 1
  v_add_u32_dpp v82, v82, v82 row_shr:8 row_mask:0xf bank_mask:0xf bound_ctrl:0
  s_nop 1
  v_add_u32_dpp v82, v82, v82 row_bcast:15 row_mask:0xa bank_mask:0xf
  s_nop 1
  v_add_u32_dpp v82, v82, v82 row_bcast:31 row_mask:0xc bank_mask:0xf
  v_sub_u32 v84, v82, v81
  v_add_u32 v85, v84, v74
  v_add_u32 v86, v84, v79
  v_add_u32 v87, v84, v80
  ds_write_b128 v72, v[84:87] offset:1024
  s_waitcnt lgkmcnt(0)
  ds_read_b32 v60, v30 offset:1024
  ds_read_b32 v61, v31 offset:1024
  ds_read_b32 v62, v32 offset:1024
  ds_read_b32 v63, v33 offset:1024
  ds_read_b32 v64, v34 offset:1024
  ds_read_b32 v65, v35 offset:1024
  ds_read_b32 v66, v36 offset:1024
  ds_read_b32 v67, v37 offset:1024
  ds_read_b32 v68, v38 offset:1024
  ds_read_b32 v69, v39 offset:1024
  s_waitcnt lgkmcnt(0)
  v_add_u32 v50, v50, v60
  v_add_u32 v51, v51, v61
  v_add_u32 v52, v52, v62
  v_add_u32 v53, v53, v63
  v_add_u32 v54, v54, v64
  v_add_u32 v55, v55, v65
  v_add_u32 v56, v56, v66
  v_add_u32 v57, v57, v67
  v_add_u32 v58, v58, v68
  v_add_u32 v59, v59, v69
  s_waitcnt vmcnt(5)
  v_lshlrev_b32 v14, 3, v14
  v_lshlrev_b32 v15, 3, v15
  v_lshlrev_b32 v16, 3, v16
  v_lshlrev_b32 v17, 3, v17
  v_lshl_or_b32 v14, v40, 21, v14
  v_lshl_or_b32 v15, v41, 21, v15
  v_lshl_or_b32 v16, v42, 21, v16
  v_lshl_or_b32 v17, v43, 21, v17
  v_lshlrev_b32 v30, 2, v50
  v_lshlrev_b32 v31, 2, v51
  v_lshlrev_b32 v32, 2, v52
  v_lshlrev_b32 v33, 2, v53
  ds_write_b32 v30, v14 offset:2048
  ds_write_b32 v31, v15 offset:2048
  ds_write_b32 v32, v16 offset:2048
  ds_write_b32 v33, v17 offset:2048
  s_waitcnt vmcnt(4)
  v_lshlrev_b32 v18, 3, v18
  v_lshlrev_b32 v19, 3, v19
  v_lshlrev_b32 v20, 3, v20
  v_lshlrev_b32 v21, 3, v21
  v_lshl_or_b32 v18, v44, 21, v18
  v_lshl_or_b32 v19, v45, 21, v19
  v_lshl_or_b32 v20, v46, 21, v20
  v_lshl_or_b32 v21, v47, 21, v21
  v_lshlrev_b32 v34, 2, v54
  v_lshlrev_b32 v35, 2, v55
  v_lshlrev_b32 v36, 2, v56
  v_lshlrev_b32 v37, 2, v57
  ds_write_b32 v34, v18 offset:2048
  ds_write_b32 v35, v19 offset:2048
  ds_write_b32 v36, v20 offset:2048
  ds_write_b32 v37, v21 offset:2048
  s_waitcnt vmcnt(3)
  v_lshlrev_b32 v22, 3, v22
  v_lshlrev_b32 v23, 3, v23
  v_lshl_or_b32 v22, v48, 21, v22
  v_lshl_or_b32 v23, v49, 21, v23
  v_lshlrev_b32 v38, 2, v58
  v_lshlrev_b32 v39, 2, v59
  ds_write_b32 v38, v22 offset:2048
  ds_write_b32 v39, v23 offset:2048
  s_cmp_lg_u32 s30, 0
  s_cbranch_scc1 L_tag1
  buffer_load_dwordx2 v[104:105], v70, s[52:55], 0 offen sc1
L_tag1:
  s_waitcnt lgkmcnt(0)
  s_barrier
  s_waitcnt vmcnt(0)
  s_cmp_lg_u32 s30, 0
  s_cbranch_scc1 L_tag3
  s_mov_b32 s40, 400000
L_tag2:
  v_readfirstlane_b32 s38, v104
  s_sub_u32 s40, s40, 1
  s_cmp_lg_u32 s38, 0
  s_cbranch_scc1 L_tag2d
  s_cmp_eq_u32 s40, 0
  s_cbranch_scc1 L_tag2d
  s_sleep 4
  buffer_load_dwordx2 v[104:105], v70, s[52:55], 0 offen sc1
  s_waitcnt vmcnt(0)
  s_branch L_tag2
L_tag2d:
  v_mov_b32 v106, 63488
  ds_write_b64 v106, v[104:105]
L_tag3:
  ds_read_b128 v[4:7], v1 offset:2048
  ds_read_b128 v[8:11], v1 offset:18432
  ds_read_b128 v[12:15], v1 offset:34816
  s_add_u32 s35, s20, 0
  s_add_u32 s36, s21, 0
  s_add_u32 s37, s22, 0
  s_waitcnt lgkmcnt(2)
  buffer_store_dwordx4 v[4:7], v1, s[12:15], s35 offen sc1
  s_waitcnt lgkmcnt(1)
  buffer_store_dwordx4 v[8:11], v1, s[12:15], s36 offen sc1
  s_waitcnt lgkmcnt(0)
  s_cmp_ge_u32 s30, 8
  s_cbranch_scc1 L_a2
  buffer_store_dwordx4 v[12:15], v1, s[12:15], s37 offen sc1
L_a2:
  v_lshlrev_b32 v60, 16, v24
  v_and_b32 v61, 0xffff0000, v24
  v_lshlrev_b32 v62, 16, v25
  v_and_b32 v63, 0xffff0000, v25
  v_mul_f32 v60, s26, v60
  v_mul_f32 v61, s26, v61
  v_mul_f32 v62, s26, v62
  v_mul_f32 v63, s26, v63
  v_cvt_pk_bf16_f32 v24, v60, v61
  v_cvt_pk_bf16_f32 v25, v62, v63
  v_lshlrev_b32 v60, 16, v24
  v_and_b32 v61, 0xffff0000, v24
  v_lshlrev_b32 v62, 16, v25
  v_and_b32 v63, 0xffff0000, v25
  v_mul_f32 v40, s28, v60
  v_mul_f32 v41, s28, v61
  v_mul_f32 v42, s28, v62
  v_mul_f32 v43, s28, v63
  v_fract_f32 v40, v40
  v_fract_f32 v41, v41
  v_fract_f32 v42, v42
  v_fract_f32 v43, v43
  v_fma_f32 v40, v60, s29, v40
  v_fma_f32 v41, v61, s29, v41
  v_fma_f32 v42, v62, s29, v42
  v_fma_f32 v43, v63, s29, v43
  v_cos_f32 v40, v40
  v_cos_f32 v41, v41
  v_cos_f32 v42, v42
  v_cos_f32 v43, v43
  v_lshlrev_b32 v30, 1, v50
  v_lshlrev_b32 v31, 1, v51
  v_lshlrev_b32 v32, 1, v52
  v_lshlrev_b32 v33, 1, v53
  v_cvt_pk_bf16_f32 v24, v40, v41
  v_cvt_pk_bf16_f32 v25, v42, v43
  ds_write_b16 v30, v24 offset:43008
  ds_write_b16_d16_hi v31, v24 offset:43008
  ds_write_b16 v32, v25 offset:43008
  ds_write_b16_d16_hi v33, v25 offset:43008
  v_lshlrev_b32 v64, 16, v26
  v_and_b32 v65, 0xffff0000, v26
  v_lshlrev_b32 v66, 16, v27
  v_and_b32 v67, 0xffff0000, v27
  v_mul_f32 v64, s26, v64
  v_mul_f32 v65, s26, v65
  v_mul_f32 v66, s26, v66
  v_mul_f32 v67, s26, v67
  v_cvt_pk_bf16_f32 v26, v64, v65
  v_cvt_pk_bf16_f32 v27, v66, v67
  v_lshlrev_b32 v64, 16, v26
  v_and_b32 v65, 0xffff0000, v26
  v_lshlrev_b32 v66, 16, v27
  v_and_b32 v67, 0xffff0000, v27
  v_mul_f32 v44, s28, v64
  v_mul_f32 v45, s28, v65
  v_mul_f32 v46, s28, v66
  v_mul_f32 v47, s28, v67
  v_fract_f32 v44, v44
  v_fract_f32 v45, v45
  v_fract_f32 v46, v46
  v_fract_f32 v47, v47
  v_fma_f32 v44, v64, s29, v44
  v_fma_f32 v45, v65, s29, v45
  v_fma_f32 v46, v66, s29, v46
  v_fma_f32 v47, v67, s29, v47
  v_cos_f32 v44, v44
  v_cos_f32 v45, v45
  v_cos_f32 v46, v46
  v_cos_f32 v47, v47
  v_lshlrev_b32 v34, 1, v54
  v_lshlrev_b32 v35, 1, v55
  v_lshlrev_b32 v36, 1, v56
  v_lshlrev_b32 v37, 1, v57
  v_cvt_pk_bf16_f32 v26, v44, v45
  v_cvt_pk_bf16_f32 v27, v46, v47
  ds_write_b16 v34, v26 offset:43008
  ds_write_b16_d16_hi v35, v26 offset:43008
  ds_write_b16 v36, v27 offset:43008
  ds_write_b16_d16_hi v37, v27 offset:43008
  v_lshlrev_b32 v68, 16, v28
  v_and_b32 v69, 0xffff0000, v28
  v_mul_f32 v68, s26, v68
  v_mul_f32 v69, s26, v69
  v_cvt_pk_bf16_f32 v28, v68, v69
  v_lshlrev_b32 v68, 16, v28
  v_and_b32 v69, 0xffff0000, v28
  v_mul_f32 v48, s28, v68
  v_mul_f32 v49, s28, v69
  v_fract_f32 v48, v48
  v_fract_f32 v49, v49
  v_fma_f32 v48, v68, s29, v48
  v_fma_f32 v49, v69, s29, v49
  v_cos_f32 v48, v48
  v_cos_f32 v49, v49
  v_lshlrev_b32 v38, 1, v58
  v_lshlrev_b32 v39, 1, v59
  v_cvt_pk_bf16_f32 v28, v48, v49
  ds_write_b16 v38, v28 offset:43008
  ds_write_b16_d16_hi v39, v28 offset:43008
  s_waitcnt lgkmcnt(0)
  s_barrier
  v_mov_b32 v106, 63488
  ds_read_b128 v[16:19], v1 offset:43008
  ds_read_b128 v[20:23], v1 offset:59392
  ds_read_b64 v[104:105], v106
  ds_read_b32 v74, v3 offset:0
  ds_read_b32 v75, v3 offset:1024
  s_add_u32 s38, s23, 10240000
  s_add_u32 s39, s23, 10256384
  s_waitcnt lgkmcnt(0)
  buffer_store_dwordx4 v[16:19], v1, s[12:15], s38 offen sc1
  v_readfirstlane_b32 s76, v104
  v_readfirstlane_b32 s77, v105
  s_cmp_ge_u32 s30, 4
  s_cbranch_scc1 L_c1
  buffer_store_dwordx4 v[20:23], v1, s[12:15], s39 offen sc1
  s_lshl_b32 s39, s2, 12
  s_lshl_b32 s40, s30, 10
  s_add_u32 s39, s39, s40
  s_add_u32 s39, s39, 15360000
  v_lshlrev_b32 v72, 4, v71
  v_mov_b32 v45, s76
  v_mov_b32 v46, s77
  v_mov_b32 v47, 0
  v_lshl_or_b32 v44, v74, 16, v75
  buffer_store_dwordx4 v[44:47], v72, s[12:15], s39 offen sc1
L_c1:
  s_barrier
  s_load_dwordx2 s[16:17], s[0:1], 88
  s_load_dwordx4 s[20:23], s[0:1], 56
  s_load_dwordx4 s[24:27], s[0:1], 72
  s_load_dwordx2 s[28:29], s[0:1], 40
  s_mov_b32 s4, s44
  s_mov_b32 s5, s45
  s_mov_b32 s6, 1280000
  s_mov_b32 s7, 0x20000
  s_mov_b32 s18, 1280000
  s_mov_b32 s19, 0x20000
  v_mov_b32 v44, 0
  v_mov_b32 v45, 0
  v_mov_b32 v46, 0
  v_mov_b32 v47, 0
  v_lshlrev_b32 v48, 4, v0
  ds_write_b128 v48, v[44:47] offset:0
  ds_write_b128 v48, v[44:47] offset:16384
  ds_write_b128 v48, v[44:47] offset:32768
  ds_write_b128 v48, v[44:47] offset:49152
  v_add_u32 v48, 0x10000, v48
  ds_write_b128 v48, v[44:47] offset:0
  ds_write_b128 v48, v[44:47] offset:16384
  ds_write_b128 v48, v[44:47] offset:32768
  ds_write_b128 v48, v[44:47] offset:49152
  v_add_u32 v48, 0x10000, v48
  ds_write_b128 v48, v[44:47] offset:0
  v_cmp_gt_u32 vcc, 580, v0
  s_and_saveexec_b64 s[34:35], vcc
  ds_write_b128 v48, v[44:47] offset:16384
  s_mov_b64 exec, s[34:35]
  v_and_b32 v1, 63, v0
  v_mov_b32 v8, 1
  s_lshl_b32 s32, s3, 4
  s_add_u32 s32, s32, 15360000
  s_mov_b32 s33, 10240000
  s_mov_b32 s79, 0
  s_mov_b32 s78, 0
  s_lshl_b32 s36, s30, 4
  v_add_u32 v6, s36, v1
  v_lshlrev_b32 v7, 12, v6
  v_lshlrev_b32 v58, 3, v6
  v_cmp_gt_u32 vcc, 250, v6
  v_cmp_gt_u32 s[38:39], 16, v1
  s_and_b64 s[80:81], vcc, s[38:39]
  s_waitcnt vmcnt(0) lgkmcnt(0)
  s_barrier
  s_cmp_lg_u32 s30, 0
  s_cbranch_scc1 L_noflag
  s_lshl_b32 s39, s2, 3
  s_add_u32 s39, s39, 16408576
  v_mov_b32 v44, s76
  v_mov_b32 v45, s77
  v_lshlrev_b32 v46, 11, v1
  s_mov_b64 exec, 255
  buffer_store_dwordx2 v[44:45], v46, s[12:15], s39 offen sc1
  s_mov_b64 exec, -1
L_noflag:
  s_mov_b32 s82, 400000
  s_mov_b64 exec, s[80:81]
  buffer_load_dwordx4 v[52:55], v7, s[12:15], s32 offen sc1
  s_mov_b64 exec, -1
  buffer_load_ushort v94, v93, s[48:51], 0 offen
  buffer_load_dwordx2 v[96:97], v92, s[44:47], 0 offen
  s_mov_b64 exec, s[80:81]
  s_waitcnt vmcnt(2)
L_tpoll:
  v_cmp_eq_u32 vcc, s76, v53
  v_cmp_eq_u32 s[38:39], s77, v54
  s_sub_u32 s82, s82, 1
  s_and_b64 vcc, vcc, s[38:39]
  s_cmp_eq_u64 vcc, s[80:81]
  s_cbranch_scc1 L_tpolled
  s_cmp_eq_u32 s82, 0
  s_cbranch_scc1 L_tpolled
  s_sleep 8
  buffer_load_dwordx4 v[52:55], v7, s[12:15], s32 offen sc1
  s_waitcnt vmcnt(0)
  s_branch L_tpoll
L_tpolled:
  s_mov_b64 exec, -1
  v_cndmask_b32 v2, 0, v52, vcc
  v_lshrrev_b32 v4, 16, v2
  v_and_b32 v2, 0xffff, v2
  s_mov_b32 s37, 10240
  v_mad_u32_u24 v2, v6, s37, v2
  v_cndmask_b32 v2, 0, v2, vcc
  v_min_u32 v5, 64, v4
  v_cmp_lt_u32 vcc, 64, v4
  s_mov_b32 s40, 0
  s_mov_b32 s41, 0
  s_cbranch_vccz L_nolong
  s_ff1_i32_b64 s42, vcc
  v_readlane_b32 s40, v2, s42
  v_readlane_b32 s41, v4, s42
  s_add_u32 s40, s40, 64
  s_sub_u32 s41, s41, 64
  s_min_u32 s41, s41, 64
  s_add_u32 s43, s41, 64
  s_mov_b32 m0, s42
  s_nop 0
  v_writelane_b32 v5, s43, m0
L_nolong:
  v_min_u32 v3, 64, v4
  v_writelane_b32 v2, s40, 16
  v_writelane_b32 v3, s41, 16
  v_sub_u32 v3, 64, v3
  v_mov_b32 v9, v2
  s_mov_b32 s84, s76
  s_mov_b32 s85, s77
  v_mov_b32 v59, 8
  v_readlane_b32 s34, v3, 0
  v_readlane_b32 s35, v2, 0
  s_lshr_b64 s[44:45], -1, s34
  s_cmp_eq_u32 s34, 64
  s_cselect_b64 s[44:45], 0, s[44:45]
  s_or_b64 exec, s[44:45], 1
  v_add_lshl_u32 v10, s35, v1, 2
  v_add_lshl_u32 v11, s35, v1, 1
  v_readlane_b32 s34, v3, 1
  v_readlane_b32 s35, v2, 1
  s_lshr_b64 s[46:47], -1, s34
  s_cmp_eq_u32 s34, 64
  s_cselect_b64 s[46:47], 0, s[46:47]
  s_or_b64 exec, s[46:47], 1
  v_add_lshl_u32 v12, s35, v1, 2
  v_add_lshl_u32 v13, s35, v1, 1
  v_readlane_b32 s34, v3, 2
  v_readlane_b32 s35, v2, 2
  s_lshr_b64 s[48:49], -1, s34
  s_cmp_eq_u32 s34, 64
  s_cselect_b64 s[48:49], 0, s[48:49]
  s_or_b64 exec, s[48:49], 1
  v_add_lshl_u32 v14, s35, v1, 2
  v_add_lshl_u32 v15, s35, v1, 1
  v_readlane_b32 s34, v3, 3
  v_readlane_b32 s35, v2, 3
  s_lshr_b64 s[50:51], -1, s34
  s_cmp_eq_u32 s34, 64
  s_cselect_b64 s[50:51], 0, s[50:51]
  s_or_b64 exec, s[50:51], 1
  v_add_lshl_u32 v16, s35, v1, 2
  v_add_lshl_u32 v17, s35, v1, 1
  v_readlane_b32 s34, v3, 4
  v_readlane_b32 s35, v2, 4
  s_lshr_b64 s[52:53], -1, s34
  s_cmp_eq_u32 s34, 64
  s_cselect_b64 s[52:53], 0, s[52:53]
  s_or_b64 exec, s[52:53], 1
  v_add_lshl_u32 v18, s35, v1, 2
  v_add_lshl_u32 v19, s35, v1, 1
  v_readlane_b32 s34, v3, 5
  v_readlane_b32 s35, v2, 5
  s_lshr_b64 s[54:55], -1, s34
  s_cmp_eq_u32 s34, 64
  s_cselect_b64 s[54:55], 0, s[54:55]
  s_or_b64 exec, s[54:55], 1
  v_add_lshl_u32 v20, s35, v1, 2
  v_add_lshl_u32 v21, s35, v1, 1
  v_readlane_b32 s34, v3, 6
  v_readlane_b32 s35, v2, 6
  s_lshr_b64 s[56:57], -1, s34
  s_cmp_eq_u32 s34, 64
  s_cselect_b64 s[56:57], 0, s[56:57]
  s_or_b64 exec, s[56:57], 1
  v_add_lshl_u32 v22, s35, v1, 2
  v_add_lshl_u32 v23, s35, v1, 1
  v_readlane_b32 s34, v3, 7
  v_readlane_b32 s35, v2, 7
  s_lshr_b64 s[58:59], -1, s34
  s_cmp_eq_u32 s34, 64
  s_cselect_b64 s[58:59], 0, s[58:59]
  s_or_b64 exec, s[58:59], 1
  v_add_lshl_u32 v24, s35, v1, 2
  v_add_lshl_u32 v25, s35, v1, 1
  v_readlane_b32 s34, v3, 8
  v_readlane_b32 s35, v2, 8
  s_lshr_b64 s[60:61], -1, s34
  s_cmp_eq_u32 s34, 64
  s_cselect_b64 s[60:61], 0, s[60:61]
  s_or_b64 exec, s[60:61], 1
  v_add_lshl_u32 v26, s35, v1, 2
  v_add_lshl_u32 v27, s35, v1, 1
  v_readlane_b32 s34, v3, 9
  v_readlane_b32 s35, v2, 9
  s_lshr_b64 s[62:63], -1, s34
  s_cmp_eq_u32 s34, 64
  s_cselect_b64 s[62:63], 0, s[62:63]
  s_or_b64 exec, s[62:63], 1
  v_add_lshl_u32 v28, s35, v1, 2
  v_add_lshl_u32 v29, s35, v1, 1
  v_readlane_b32 s34, v3, 10
  v_readlane_b32 s35, v2, 10
  s_lshr_b64 s[64:65], -1, s34
  s_cmp_eq_u32 s34, 64
  s_cselect_b64 s[64:65], 0, s[64:65]
  s_or_b64 exec, s[64:65], 1
  v_add_lshl_u32 v30, s35, v1, 2
  v_add_lshl_u32 v31, s35, v1, 1
  v_readlane_b32 s34, v3, 11
  v_readlane_b32 s35, v2, 11
  s_lshr_b64 s[66:67], -1, s34
  s_cmp_eq_u32 s34, 64
  s_cselect_b64 s[66:67], 0, s[66:67]
  s_or_b64 exec, s[66:67], 1
  v_add_lshl_u32 v32, s35, v1, 2
  v_add_lshl_u32 v33, s35, v1, 1
  v_readlane_b32 s34, v3, 12
  v_readlane_b32 s35, v2, 12
  s_lshr_b64 s[68:69], -1, s34
  s_cmp_eq_u32 s34, 64
  s_cselect_b64 s[68:69], 0, s[68:69]
  s_or_b64 exec, s[68:69], 1
  v_add_lshl_u32 v34, s35, v1, 2
  v_add_lshl_u32 v35, s35, v1, 1
  v_readlane_b32 s34, v3, 13
  v_readlane_b32 s35, v2, 13
  s_lshr_b64 s[70:71], -1, s34
  s_cmp_eq_u32 s34, 64
  s_cselect_b64 s[70:71], 0, s[70:71]
  s_or_b64 exec, s[70:71], 1
  v_add_lshl_u32 v36, s35, v1, 2
  v_add_lshl_u32 v37, s35, v1, 1
  v_readlane_b32 s34, v3, 14
  v_readlane_b32 s35, v2, 14
  s_lshr_b64 s[72:73], -1, s34
  s_cmp_eq_u32 s34, 64
  s_cselect_b64 s[72:73], 0, s[72:73]
  s_or_b64 exec, s[72:73], 1
  v_add_lshl_u32 v38, s35, v1, 2
  v_add_lshl_u32 v39, s35, v1, 1
  v_readlane_b32 s34, v3, 15
  v_readlane_b32 s35, v2, 15
  s_lshr_b64 s[74:75], -1, s34
  s_cmp_eq_u32 s34, 64
  s_cselect_b64 s[74:75], 0, s[74:75]
  s_or_b64 exec, s[74:75], 1
  v_add_lshl_u32 v40, s35, v1, 2
  v_add_lshl_u32 v41, s35, v1, 1
  v_readlane_b32 s34, v3, 16
  v_readlane_b32 s35, v2, 16
  s_lshr_b64 s[76:77], -1, s34
  s_cmp_eq_u32 s34, 64
  s_cselect_b64 s[76:77], 0, s[76:77]
  s_or_b64 exec, s[76:77], 1
  v_add_lshl_u32 v42, s35, v1, 2
  v_add_lshl_u32 v43, s35, v1, 1
  s_mov_b32 s37, 52
  s_and_b32 s83, s2, 7
  s_lshl_b32 s83, s83, 11
  s_add_u32 s83, s83, 16408576
  s_mov_b32 s82, 400000
  s_mov_b64 exec, s[80:81]
L_poll:
  buffer_load_dwordx2 v[56:57], v58, s[12:15], s83 offen sc1
L_poll1:
  s_waitcnt vmcnt(0)
  v_cmp_eq_u32 vcc, s84, v56
  v_cmp_eq_u32 s[38:39], s85, v57
  s_sub_u32 s82, s82, 1
  s_and_b64 vcc, vcc, s[38:39]
  s_cmp_eq_u64 vcc, s[80:81]
  s_cbranch_scc1 L_polled
  s_cmp_eq_u32 s82, 0
  s_cbranch_scc1 L_polled
  s_sleep 4
  s_branch L_poll
L_polled:
  s_or_b64 exec, s[44:45], 1
  buffer_load_dword v10, v10, s[12:15], s79 offen sc1
  buffer_load_ushort v11, v11, s[12:15], s33 offen sc1
  s_or_b64 exec, s[46:47], 1
  buffer_load_dword v12, v12, s[12:15], s79 offen sc1
  buffer_load_ushort v13, v13, s[12:15], s33 offen sc1
  s_or_b64 exec, s[48:49], 1
  buffer_load_dword v14, v14, s[12:15], s79 offen sc1
  buffer_load_ushort v15, v15, s[12:15], s33 offen sc1
  s_or_b64 exec, s[50:51], 1
  buffer_load_dword v16, v16, s[12:15], s79 offen sc1
  buffer_load_ushort v17, v17, s[12:15], s33 offen sc1
  s_or_b64 exec, s[52:53], 1
  buffer_load_dword v18, v18, s[12:15], s79 offen sc1
  buffer_load_ushort v19, v19, s[12:15], s33 offen sc1
  s_or_b64 exec, s[54:55], 1
  buffer_load_dword v20, v20, s[12:15], s79 offen sc1
  buffer_load_ushort v21, v21, s[12:15], s33 offen sc1
  s_or_b64 exec, s[56:57], 1
  buffer_load_dword v22, v22, s[12:15], s79 offen sc1
  buffer_load_ushort v23, v23, s[12:15], s33 offen sc1
  s_or_b64 exec, s[58:59], 1
  buffer_load_dword v24, v24, s[12:15], s79 offen sc1
  buffer_load_ushort v25, v25, s[12:15], s33 offen sc1
  s_waitcnt vmcnt(14)
  s_mov_b64 exec, s[44:45]
  v_lshrrev_b32 v44, 9, v10
  v_and_b32 v44, 0xffc, v44
  ds_add_rtn_u32 v53, v44, v59 offset:20480
  v_lshl_or_b32 v11, v11, 16, 1
  s_waitcnt vmcnt(12)
  s_mov_b64 exec, s[46:47]
  v_lshrrev_b32 v45, 9, v12
  v_and_b32 v45, 0xffc, v45
  ds_add_rtn_u32 v54, v45, v59 offset:20480
  v_lshl_or_b32 v13, v13, 16, 1
  s_waitcnt vmcnt(10)
  s_mov_b64 exec, s[48:49]
  v_lshrrev_b32 v46, 9, v14
  v_and_b32 v46, 0xffc, v46
  ds_add_rtn_u32 v55, v46, v59 offset:20480
  v_lshl_or_b32 v15, v15, 16, 1
  s_waitcnt vmcnt(8)
  s_mov_b64 exec, s[50:51]
  v_lshrrev_b32 v47, 9, v16
  v_and_b32 v47, 0xffc, v47
  ds_add_rtn_u32 v56, v47, v59 offset:20480
  v_lshl_or_b32 v17, v17, 16, 1
  s_waitcnt lgkmcnt(0)
  s_mov_b64 exec, s[44:45]
  v_cmp_le_u32 vcc, 208, v53
  v_mad_u32_u24 v44, v44, s37, v53
  s_cbranch_vccnz L_ovf0
L_back0:
  ds_write_b64 v44, v[10:11] offset:25664
  s_mov_b64 exec, s[46:47]
  v_cmp_le_u32 vcc, 208, v54
  v_mad_u32_u24 v45, v45, s37, v54
  s_cbranch_vccnz L_ovf1
L_back1:
  ds_write_b64 v45, v[12:13] offset:25664
  s_mov_b64 exec, s[48:49]
  v_cmp_le_u32 vcc, 208, v55
  v_mad_u32_u24 v46, v46, s37, v55
  s_cbranch_vccnz L_ovf2
L_back2:
  ds_write_b64 v46, v[14:15] offset:25664
  s_mov_b64 exec, s[50:51]
  v_cmp_le_u32 vcc, 208, v56
  v_mad_u32_u24 v47, v47, s37, v56
  s_cbranch_vccnz L_ovf3
L_back3:
  ds_write_b64 v47, v[16:17] offset:25664
  s_or_b64 exec, s[60:61], 1
  buffer_load_dword v26, v26, s[12:15], s79 offen sc1
  buffer_load_ushort v27, v27, s[12:15], s33 offen sc1
  s_or_b64 exec, s[62:63], 1
  buffer_load_dword v28, v28, s[12:15], s79 offen sc1
  buffer_load_ushort v29, v29, s[12:15], s33 offen sc1
  s_or_b64 exec, s[64:65], 1
  buffer_load_dword v30, v30, s[12:15], s79 offen sc1
  buffer_load_ushort v31, v31, s[12:15], s33 offen sc1
  s_or_b64 exec, s[66:67], 1
  buffer_load_dword v32, v32, s[12:15], s79 offen sc1
  buffer_load_ushort v33, v33, s[12:15], s33 offen sc1
  s_waitcnt vmcnt(14)
  s_mov_b64 exec, s[52:53]
  v_lshrrev_b32 v44, 9, v18
  v_and_b32 v44, 0xffc, v44
  ds_add_rtn_u32 v53, v44, v59 offset:20480
  v_lshl_or_b32 v19, v19, 16, 1
  s_waitcnt vmcnt(12)
  s_mov_b64 exec, s[54:55]
  v_lshrrev_b32 v45, 9, v20
  v_and_b32 v45, 0xffc, v45
  ds_add_rtn_u32 v54, v45, v59 offset:20480
  v_lshl_or_b32 v21, v21, 16, 1
  s_waitcnt vmcnt(10)
  s_mov_b64 exec, s[56:57]
  v_lshrrev_b32 v46, 9, v22
  v_and_b32 v46, 0xffc, v46
  ds_add_rtn_u32 v55, v46, v59 offset:20480
  v_lshl_or_b32 v23, v23, 16, 1
  s_waitcnt vmcnt(8)
  s_mov_b64 exec, s[58:59]
  v_lshrrev_b32 v47, 9, v24
  v_and_b32 v47, 0xffc, v47
  ds_add_rtn_u32 v56, v47, v59 offset:20480
  v_lshl_or_b32 v25, v25, 16, 1
  s_waitcnt lgkmcnt(0)
  s_mov_b64 exec, s[52:53]
  v_cmp_le_u32 vcc, 208, v53
  v_mad_u32_u24 v44, v44, s37, v53
  s_cbranch_vccnz L_ovf4
L_back4:
  ds_write_b64 v44, v[18:19] offset:25664
  s_mov_b64 exec, s[54:55]
  v_cmp_le_u32 vcc, 208, v54
  v_mad_u32_u24 v45, v45, s37, v54
  s_cbranch_vccnz L_ovf5
L_back5:
  ds_write_b64 v45, v[20:21] offset:25664
  s_mov_b64 exec, s[56:57]
  v_cmp_le_u32 vcc, 208, v55
  v_mad_u32_u24 v46, v46, s37, v55
  s_cbranch_vccnz L_ovf6
L_back6:
  ds_write_b64 v46, v[22:23] offset:25664
  s_mov_b64 exec, s[58:59]
  v_cmp_le_u32 vcc, 208, v56
  v_mad_u32_u24 v47, v47, s37, v56
  s_cbranch_vccnz L_ovf7
L_back7:
  ds_write_b64 v47, v[24:25] offset:25664
  s_or_b64 exec, s[68:69], 1
  buffer_load_dword v34, v34, s[12:15], s79 offen sc1
  buffer_load_ushort v35, v35, s[12:15], s33 offen sc1
  s_or_b64 exec, s[70:71], 1
  buffer_load_dword v36, v36, s[12:15], s79 offen sc1
  buffer_load_ushort v37, v37, s[12:15], s33 offen sc1
  s_or_b64 exec, s[72:73], 1
  buffer_load_dword v38, v38, s[12:15], s79 offen sc1
  buffer_load_ushort v39, v39, s[12:15], s33 offen sc1
  s_or_b64 exec, s[74:75], 1
  buffer_load_dword v40, v40, s[12:15], s79 offen sc1
  buffer_load_ushort v41, v41, s[12:15], s33 offen sc1
  s_or_b64 exec, s[76:77], 1
  buffer_load_dword v42, v42, s[12:15], s79 offen sc1
  buffer_load_ushort v43, v43, s[12:15], s33 offen sc1
  s_waitcnt vmcnt(16)
  s_mov_b64 exec, s[60:61]
  v_lshrrev_b32 v44, 9, v26
  v_and_b32 v44, 0xffc, v44
  ds_add_rtn_u32 v53, v44, v59 offset:20480
  v_lshl_or_b32 v27, v27, 16, 1
  s_waitcnt vmcnt(14)
  s_mov_b64 exec, s[62:63]
  v_lshrrev_b32 v45, 9, v28
  v_and_b32 v45, 0xffc, v45
  ds_add_rtn_u32 v54, v45, v59 offset:20480
  v_lshl_or_b32 v29, v29, 16, 1
  s_waitcnt vmcnt(12)
  s_mov_b64 exec, s[64:65]
  v_lshrrev_b32 v46, 9, v30
  v_and_b32 v46, 0xffc, v46
  ds_add_rtn_u32 v55, v46, v59 offset:20480
  v_lshl_or_b32 v31, v31, 16, 1
  s_waitcnt vmcnt(10)
  s_mov_b64 exec, s[66:67]
  v_lshrrev_b32 v47, 9, v32
  v_and_b32 v47, 0xffc, v47
  ds_add_rtn_u32 v56, v47, v59 offset:20480
  v_lshl_or_b32 v33, v33, 16, 1
  s_waitcnt lgkmcnt(0)
  s_mov_b64 exec, s[60:61]
  v_cmp_le_u32 vcc, 208, v53
  v_mad_u32_u24 v44, v44, s37, v53
  s_cbranch_vccnz L_ovf8
L_back8:
  ds_write_b64 v44, v[26:27] offset:25664
  s_mov_b64 exec, s[62:63]
  v_cmp_le_u32 vcc, 208, v54
  v_mad_u32_u24 v45, v45, s37, v54
  s_cbranch_vccnz L_ovf9
L_back9:
  ds_write_b64 v45, v[28:29] offset:25664
  s_mov_b64 exec, s[64:65]
  v_cmp_le_u32 vcc, 208, v55
  v_mad_u32_u24 v46, v46, s37, v55
  s_cbranch_vccnz L_ovf10
L_back10:
  ds_write_b64 v46, v[30:31] offset:25664
  s_mov_b64 exec, s[66:67]
  v_cmp_le_u32 vcc, 208, v56
  v_mad_u32_u24 v47, v47, s37, v56
  s_cbranch_vccnz L_ovf11
L_back11:
  ds_write_b64 v47, v[32:33] offset:25664
  s_waitcnt vmcnt(8)
  s_mov_b64 exec, s[68:69]
  v_lshrrev_b32 v44, 9, v34
  v_and_b32 v44, 0xffc, v44
  ds_add_rtn_u32 v53, v44, v59 offset:20480
  v_lshl_or_b32 v35, v35, 16, 1
  s_waitcnt vmcnt(6)
  s_mov_b64 exec, s[70:71]
  v_lshrrev_b32 v45, 9, v36
  v_and_b32 v45, 0xffc, v45
  ds_add_rtn_u32 v54, v45, v59 offset:20480
  v_lshl_or_b32 v37, v37, 16, 1
  s_waitcnt vmcnt(4)
  s_mov_b64 exec, s[72:73]
  v_lshrrev_b32 v46, 9, v38
  v_and_b32 v46, 0xffc, v46
  ds_add_rtn_u32 v55, v46, v59 offset:20480
  v_lshl_or_b32 v39, v39, 16, 1
  s_waitcnt vmcnt(2)
  s_mov_b64 exec, s[74:75]
  v_lshrrev_b32 v47, 9, v40
  v_and_b32 v47, 0xffc, v47
  ds_add_rtn_u32 v56, v47, v59 offset:20480
  v_lshl_or_b32 v41, v41, 16, 1
  s_waitcnt vmcnt(0)
  s_mov_b64 exec, s[76:77]
  v_lshrrev_b32 v48, 9, v42
  v_and_b32 v48, 0xffc, v48
  ds_add_rtn_u32 v57, v48, v59 offset:20480
  v_lshl_or_b32 v43, v43, 16, 1
  s_waitcnt lgkmcnt(0)
  s_mov_b64 exec, s[68:69]
  v_cmp_le_u32 vcc, 208, v53
  v_mad_u32_u24 v44, v44, s37, v53
  s_cbranch_vccnz L_ovf12
L_back12:
  ds_write_b64 v44, v[34:35] offset:25664
  s_mov_b64 exec, s[70:71]
  v_cmp_le_u32 vcc, 208, v54
  v_mad_u32_u24 v45, v45, s37, v54
  s_cbranch_vccnz L_ovf13
L_back13:
  ds_write_b64 v45, v[36:37] offset:25664
  s_mov_b64 exec, s[72:73]
  v_cmp_le_u32 vcc, 208, v55
  v_mad_u32_u24 v46, v46, s37, v55
  s_cbranch_vccnz L_ovf14
L_back14:
  ds_write_b64 v46, v[38:39] offset:25664
  s_mov_b64 exec, s[74:75]
  v_cmp_le_u32 vcc, 208, v56
  v_mad_u32_u24 v47, v47, s37, v56
  s_cbranch_vccnz L_ovf15
L_back15:
  ds_write_b64 v47, v[40:41] offset:25664
  s_mov_b64 exec, s[76:77]
  v_cmp_le_u32 vcc, 208, v57
  v_mad_u32_u24 v48, v48, s37, v57
  s_cbranch_vccnz L_ovf16
L_back16:
  ds_write_b64 v48, v[42:43] offset:25664
  s_mov_b64 exec, -1
  s_waitcnt vmcnt(0) lgkmcnt(0)
  s_barrier
  v_mov_b32 v6, 0
  s_lshl_b32 s34, s30, 13
  v_lshlrev_b32 v7, 3, v1
  ds_read_b32 v6, v6 offset:25604
  s_add_u32 s34, s34, 25664
  v_add_u32 v7, s34, v7
  ds_read_b64 v[10:11], v7 offset:0
  ds_read_b64 v[12:13], v7 offset:512
  ds_read_b64 v[14:15], v7 offset:1024
  ds_read_b64 v[16:17], v7 offset:1536
  ds_read_b64 v[18:19], v7 offset:2048
  ds_read_b64 v[20:21], v7 offset:2560
  ds_read_b64 v[22:23], v7 offset:3072
  ds_read_b64 v[24:25], v7 offset:3584
  ds_read_b64 v[26:27], v7 offset:4096
  ds_read_b64 v[28:29], v7 offset:4608
  ds_read_b64 v[30:31], v7 offset:5120
  ds_read_b64 v[32:33], v7 offset:5632
  ds_read_b64 v[34:35], v7 offset:6144
  ds_read_b64 v[36:37], v7 offset:6656
  ds_read_b64 v[38:39], v7 offset:7168
  ds_read_b64 v[40:41], v7 offset:7680
  s_waitcnt lgkmcnt(0)
  v_readfirstlane_b32 s34, v6
  s_cmp_lg_u32 s34, 0
  s_cbranch_scc1 L_panic
  v_cmp_ne_u32 s[44:45], 0, v11
  v_cmp_ne_u32 s[46:47], 0, v13
  v_cmp_ne_u32 s[48:49], 0, v15
  v_cmp_ne_u32 s[50:51], 0, v17
  v_cmp_ne_u32 s[52:53], 0, v19
  v_cmp_ne_u32 s[54:55], 0, v21
  v_cmp_ne_u32 s[56:57], 0, v23
  v_cmp_ne_u32 s[58:59], 0, v25
  v_cmp_ne_u32 s[60:61], 0, v27
  v_cmp_ne_u32 s[62:63], 0, v29
  v_cmp_ne_u32 s[64:65], 0, v31
  v_cmp_ne_u32 s[66:67], 0, v33
  v_cmp_ne_u32 s[68:69], 0, v35
  v_cmp_ne_u32 s[70:71], 0, v37
  v_cmp_ne_u32 s[72:73], 0, v39
  v_cmp_ne_u32 s[74:75], 0, v41
  v_and_b32 v44, 0x1fffff, v10
  v_and_b32 v46, 0x1fffff, v12
  v_and_b32 v48, 0x1fffff, v14
  v_and_b32 v50, 0x1fffff, v16
  v_and_b32 v52, 0x1fffff, v18
  v_and_b32 v54, 0x1fffff, v20
  v_and_b32 v56, 0x1fffff, v22
  v_and_b32 v58, 0x1fffff, v24
  v_and_b32 v60, 0x1fffff, v26
  v_and_b32 v62, 0x1fffff, v28
  v_and_b32 v64, 0x1fffff, v30
  v_and_b32 v66, 0x1fffff, v32
  v_and_b32 v68, 0x1fffff, v34
  v_and_b32 v70, 0x1fffff, v36
  v_and_b32 v72, 0x1fffff, v38
  v_and_b32 v74, 0x1fffff, v40
  s_cmp_lt_u32 s30, 4
  s_cbranch_scc1 L_gath
L_side:
  s_mov_b32 s36, 5120
  s_mov_b64 exec, s[44:45]
  v_lshrrev_b32 v78, 18, v10
  v_and_b32 v78, 0x1ff8, v78
  v_lshrrev_b32 v82, 1, v78
  ds_add_rtn_u32 v86, v82, v8 offset:23040
  v_or_b32 v82, 0x80000000, v78
  s_mov_b64 exec, s[46:47]
  v_lshrrev_b32 v79, 18, v12
  v_and_b32 v79, 0x1ff8, v79
  v_lshrrev_b32 v83, 1, v79
  ds_add_rtn_u32 v87, v83, v8 offset:23040
  v_or_b32 v83, 0x80000000, v79
  s_mov_b64 exec, s[48:49]
  v_lshrrev_b32 v80, 18, v14
  v_and_b32 v80, 0x1ff8, v80
  v_lshrrev_b32 v84, 1, v80
  ds_add_rtn_u32 v88, v84, v8 offset:23040
  v_or_b32 v84, 0x80000000, v80
  s_mov_b64 exec, s[50:51]
  v_lshrrev_b32 v81, 18, v16
  v_and_b32 v81, 0x1ff8, v81
  v_lshrrev_b32 v85, 1, v81
  ds_add_rtn_u32 v89, v85, v8 offset:23040
  v_or_b32 v85, 0x80000000, v81
  s_waitcnt lgkmcnt(0)
  s_mov_b64 exec, s[44:45]
  v_cmp_le_u32 vcc, 25, v86
  v_mad_u32_u24 v78, v86, s36, v78
  s_nop 0
  v_cndmask_b32 v10, v78, v82, vcc
  s_mov_b64 exec, s[46:47]
  v_cmp_le_u32 vcc, 25, v87
  v_mad_u32_u24 v79, v87, s36, v79
  s_nop 0
  v_cndmask_b32 v12, v79, v83, vcc
  s_mov_b64 exec, s[48:49]
  v_cmp_le_u32 vcc, 25, v88
  v_mad_u32_u24 v80, v88, s36, v80
  s_nop 0
  v_cndmask_b32 v14, v80, v84, vcc
  s_mov_b64 exec, s[50:51]
  v_cmp_le_u32 vcc, 25, v89
  v_mad_u32_u24 v81, v89, s36, v81
  s_nop 0
  v_cndmask_b32 v16, v81, v85, vcc
  s_mov_b64 exec, s[52:53]
  v_lshrrev_b32 v78, 18, v18
  v_and_b32 v78, 0x1ff8, v78
  v_lshrrev_b32 v82, 1, v78
  ds_add_rtn_u32 v86, v82, v8 offset:23040
  v_or_b32 v82, 0x80000000, v78
  s_mov_b64 exec, s[54:55]
  v_lshrrev_b32 v79, 18, v20
  v_and_b32 v79, 0x1ff8, v79
  v_lshrrev_b32 v83, 1, v79
  ds_add_rtn_u32 v87, v83, v8 offset:23040
  v_or_b32 v83, 0x80000000, v79
  s_mov_b64 exec, s[56:57]
  v_lshrrev_b32 v80, 18, v22
  v_and_b32 v80, 0x1ff8, v80
  v_lshrrev_b32 v84, 1, v80
  ds_add_rtn_u32 v88, v84, v8 offset:23040
  v_or_b32 v84, 0x80000000, v80
  s_mov_b64 exec, s[58:59]
  v_lshrrev_b32 v81, 18, v24
  v_and_b32 v81, 0x1ff8, v81
  v_lshrrev_b32 v85, 1, v81
  ds_add_rtn_u32 v89, v85, v8 offset:23040
  v_or_b32 v85, 0x80000000, v81
  s_waitcnt lgkmcnt(0)
  s_mov_b64 exec, s[52:53]
  v_cmp_le_u32 vcc, 25, v86
  v_mad_u32_u24 v78, v86, s36, v78
  s_nop 0
  v_cndmask_b32 v18, v78, v82, vcc
  s_mov_b64 exec, s[54:55]
  v_cmp_le_u32 vcc, 25, v87
  v_mad_u32_u24 v79, v87, s36, v79
  s_nop 0
  v_cndmask_b32 v20, v79, v83, vcc
  s_mov_b64 exec, s[56:57]
  v_cmp_le_u32 vcc, 25, v88
  v_mad_u32_u24 v80, v88, s36, v80
  s_nop 0
  v_cndmask_b32 v22, v80, v84, vcc
  s_mov_b64 exec, s[58:59]
  v_cmp_le_u32 vcc, 25, v89
  v_mad_u32_u24 v81, v89, s36, v81
  s_nop 0
  v_cndmask_b32 v24, v81, v85, vcc
  s_mov_b64 exec, s[60:61]
  v_lshrrev_b32 v78, 18, v26
  v_and_b32 v78, 0x1ff8, v78
  v_lshrrev_b32 v82, 1, v78
  ds_add_rtn_u32 v86, v82, v8 offset:23040
  v_or_b32 v82, 0x80000000, v78
  s_mov_b64 exec, s[62:63]
  v_lshrrev_b32 v79, 18, v28
  v_and_b32 v79, 0x1ff8, v79
  v_lshrrev_b32 v83, 1, v79
  ds_add_rtn_u32 v87, v83, v8 offset:23040
  v_or_b32 v83, 0x80000000, v79
  s_mov_b64 exec, s[64:65]
  v_lshrrev_b32 v80, 18, v30
  v_and_b32 v80, 0x1ff8, v80
  v_lshrrev_b32 v84, 1, v80
  ds_add_rtn_u32 v88, v84, v8 offset:23040
  v_or_b32 v84, 0x80000000, v80
  s_mov_b64 exec, s[66:67]
  v_lshrrev_b32 v81, 18, v32
  v_and_b32 v81, 0x1ff8, v81
  v_lshrrev_b32 v85, 1, v81
  ds_add_rtn_u32 v89, v85, v8 offset:23040
  v_or_b32 v85, 0x80000000, v81
  s_waitcnt lgkmcnt(0)
  s_mov_b64 exec, s[60:61]
  v_cmp_le_u32 vcc, 25, v86
  v_mad_u32_u24 v78, v86, s36, v78
  s_nop 0
  v_cndmask_b32 v26, v78, v82, vcc
  s_mov_b64 exec, s[62:63]
  v_cmp_le_u32 vcc, 25, v87
  v_mad_u32_u24 v79, v87, s36, v79
  s_nop 0
  v_cndmask_b32 v28, v79, v83, vcc
  s_mov_b64 exec, s[64:65]
  v_cmp_le_u32 vcc, 25, v88
  v_mad_u32_u24 v80, v88, s36, v80
  s_nop 0
  v_cndmask_b32 v30, v80, v84, vcc
  s_mov_b64 exec, s[66:67]
  v_cmp_le_u32 vcc, 25, v89
  v_mad_u32_u24 v81, v89, s36, v81
  s_nop 0
  v_cndmask_b32 v32, v81, v85, vcc
  s_mov_b64 exec, s[68:69]
  v_lshrrev_b32 v78, 18, v34
  v_and_b32 v78, 0x1ff8, v78
  v_lshrrev_b32 v82, 1, v78
  ds_add_rtn_u32 v86, v82, v8 offset:23040
  v_or_b32 v82, 0x80000000, v78
  s_mov_b64 exec, s[70:71]
  v_lshrrev_b32 v79, 18, v36
  v_and_b32 v79, 0x1ff8, v79
  v_lshrrev_b32 v83, 1, v79
  ds_add_rtn_u32 v87, v83, v8 offset:23040
  v_or_b32 v83, 0x80000000, v79
  s_mov_b64 exec, s[72:73]
  v_lshrrev_b32 v80, 18, v38
  v_and_b32 v80, 0x1ff8, v80
  v_lshrrev_b32 v84, 1, v80
  ds_add_rtn_u32 v88, v84, v8 offset:23040
  v_or_b32 v84, 0x80000000, v80
  s_mov_b64 exec, s[74:75]
  v_lshrrev_b32 v81, 18, v40
  v_and_b32 v81, 0x1ff8, v81
  v_lshrrev_b32 v85, 1, v81
  ds_add_rtn_u32 v89, v85, v8 offset:23040
  v_or_b32 v85, 0x80000000, v81
  s_waitcnt lgkmcnt(0)
  s_mov_b64 exec, s[68:69]
  v_cmp_le_u32 vcc, 25, v86
  v_mad_u32_u24 v78, v86, s36, v78
  s_nop 0
  v_cndmask_b32 v34, v78, v82, vcc
  s_mov_b64 exec, s[70:71]
  v_cmp_le_u32 vcc, 25, v87
  v_mad_u32_u24 v79, v87, s36, v79
  s_nop 0
  v_cndmask_b32 v36, v79, v83, vcc
  s_mov_b64 exec, s[72:73]
  v_cmp_le_u32 vcc, 25, v88
  v_mad_u32_u24 v80, v88, s36, v80
  s_nop 0
  v_cndmask_b32 v38, v80, v84, vcc
  s_mov_b64 exec, s[74:75]
  v_cmp_le_u32 vcc, 25, v89
  v_mad_u32_u24 v81, v89, s36, v81
  s_nop 0
  v_cndmask_b32 v40, v81, v85, vcc
  s_mov_b64 exec, -1
  s_cmp_lt_u32 s30, 4
  s_cbranch_scc1 L_side2
  v_mov_b32 v118, 0
  v_mov_b32 v119, 0
  ds_write_b64 v7, v[118:119] offset:0
  ds_write_b64 v7, v[118:119] offset:512
  ds_write_b64 v7, v[118:119] offset:1024
  ds_write_b64 v7, v[118:119] offset:1536
  ds_write_b64 v7, v[118:119] offset:2048
  ds_write_b64 v7, v[118:119] offset:2560
  ds_write_b64 v7, v[118:119] offset:3072
  ds_write_b64 v7, v[118:119] offset:3584
  ds_write_b64 v7, v[118:119] offset:4096
  ds_write_b64 v7, v[118:119] offset:4608
  ds_write_b64 v7, v[118:119] offset:5120
  ds_write_b64 v7, v[118:119] offset:5632
  ds_write_b64 v7, v[118:119] offset:6144
  ds_write_b64 v7, v[118:119] offset:6656
  ds_write_b64 v7, v[118:119] offset:7168
  ds_write_b64 v7, v[118:119] offset:7680
  s_waitcnt lgkmcnt(0)
  s_barrier
L_side2:
  s_cmp_ge_u32 s30, 10
  s_cbranch_scc1 L_nopre
L_pre:
  s_load_dwordx4 s[96:99], s[28:29], 0
  s_load_dwordx16 s[80:95], s[22:23], 0
  v_lshlrev_b32 v94, 16, v94
  s_mov_b32 s34, 0xc1200000
  s_mov_b32 s35, 0x3fb8aa3b
  s_waitcnt lgkmcnt(0)
  s_lshl_b32 s36, s96, 16
  s_and_b32 s37, s96, 0xffff0000
  v_subrev_f32 v78, s36, v94
  v_subrev_f32 v79, s37, v94
  v_cvt_pk_bf16_f32 v95, v78, v79
  v_lshlrev_b32 v78, 16, v95
  v_and_b32 v79, 0xffff0000, v95
  v_mul_f32 v78, v78, v78
  v_mul_f32 v79, v79, v79
  v_cvt_pk_bf16_f32 v95, v78, v79
  v_lshlrev_b32 v78, 16, v95
  v_and_b32 v79, 0xffff0000, v95
  v_mul_f32 v78, s34, v78
  v_mul_f32 v79, s34, v79
  v_cvt_pk_bf16_f32 v95, v78, v79
  v_lshlrev_b32 v78, 16, v95
  v_and_b32 v79, 0xffff0000, v95
  v_mul_f32 v78, s35, v78
  v_mul_f32 v79, s35, v79
  v_exp_f32 v78, v78
  v_exp_f32 v79, v79
  s_nop 0
  v_cvt_pk_bf16_f32 v95, v78, v79
  v_lshlrev_b32 v78, 16, v95
  v_and_b32 v79, 0xffff0000, v95
  s_lshl_b32 s36, s97, 16
  s_and_b32 s37, s97, 0xffff0000
  v_subrev_f32 v80, s36, v94
  v_subrev_f32 v81, s37, v94
  v_cvt_pk_bf16_f32 v95, v80, v81
  v_lshlrev_b32 v80, 16, v95
  v_and_b32 v81, 0xffff0000, v95
  v_mul_f32 v80, v80, v80
  v_mul_f32 v81, v81, v81
  v_cvt_pk_bf16_f32 v95, v80, v81
  v_lshlrev_b32 v80, 16, v95
  v_and_b32 v81, 0xffff0000, v95
  v_mul_f32 v80, s34, v80
  v_mul_f32 v81, s34, v81
  v_cvt_pk_bf16_f32 v95, v80, v81
  v_lshlrev_b32 v80, 16, v95
  v_and_b32 v81, 0xffff0000, v95
  v_mul_f32 v80, s35, v80
  v_mul_f32 v81, s35, v81
  v_exp_f32 v80, v80
  v_exp_f32 v81, v81
  s_nop 0
  v_cvt_pk_bf16_f32 v95, v80, v81
  v_lshlrev_b32 v80, 16, v95
  v_and_b32 v81, 0xffff0000, v95
  s_lshl_b32 s36, s98, 16
  s_and_b32 s37, s98, 0xffff0000
  v_subrev_f32 v82, s36, v94
  v_subrev_f32 v83, s37, v94
  v_cvt_pk_bf16_f32 v95, v82, v83
  v_lshlrev_b32 v82, 16, v95
  v_and_b32 v83, 0xffff0000, v95
  v_mul_f32 v82, v82, v82
  v_mul_f32 v83, v83, v83
  v_cvt_pk_bf16_f32 v95, v82, v83
  v_lshlrev_b32 v82, 16, v95
  v_and_b32 v83, 0xffff0000, v95
  v_mul_f32 v82, s34, v82
  v_mul_f32 v83, s34, v83
  v_cvt_pk_bf16_f32 v95, v82, v83
  v_lshlrev_b32 v82, 16, v95
  v_and_b32 v83, 0xffff0000, v95
  v_mul_f32 v82, s35, v82
  v_mul_f32 v83, s35, v83
  v_exp_f32 v82, v82
  v_exp_f32 v83, v83
  s_nop 0
  v_cvt_pk_bf16_f32 v95, v82, v83
  v_lshlrev_b32 v82, 16, v95
  v_and_b32 v83, 0xffff0000, v95
  s_lshl_b32 s36, s99, 16
  s_and_b32 s37, s99, 0xffff0000
  v_subrev_f32 v84, s36, v94
  v_subrev_f32 v85, s37, v94
  v_cvt_pk_bf16_f32 v95, v84, v85
  v_lshlrev_b32 v84, 16, v95
  v_and_b32 v85, 0xffff0000, v95
  v_mul_f32 v84, v84, v84
  v_mul_f32 v85, v85, v85
  v_cvt_pk_bf16_f32 v95, v84, v85
  v_lshlrev_b32 v84, 16, v95
  v_and_b32 v85, 0xffff0000, v95
  v_mul_f32 v84, s34, v84
  v_mul_f32 v85, s34, v85
  v_cvt_pk_bf16_f32 v95, v84, v85
  v_lshlrev_b32 v84, 16, v95
  v_and_b32 v85, 0xffff0000, v95
  v_mul_f32 v84, s35, v84
  v_mul_f32 v85, s35, v85
  v_exp_f32 v84, v84
  v_exp_f32 v85, v85
  s_nop 0
  v_cvt_pk_bf16_f32 v95, v84, v85
  v_lshlrev_b32 v84, 16, v95
  v_and_b32 v85, 0xffff0000, v95
  s_lshl_b32 s40, s80, 16
  s_and_b32 s41, s80, 0xffff0000
  s_lshl_b32 s42, s81, 16
  s_and_b32 s43, s81, 0xffff0000
  v_mul_f32 v86, s40, v78
  v_mul_f32 v87, s41, v78
  v_mul_f32 v88, s42, v78
  v_mul_f32 v89, s43, v78
  s_lshl_b32 s40, s82, 16
  s_and_b32 s41, s82, 0xffff0000
  s_lshl_b32 s42, s83, 16
  s_and_b32 s43, s83, 0xffff0000
  v_fmac_f32 v86, s40, v79
  v_fmac_f32 v87, s41, v79
  v_fmac_f32 v88, s42, v79
  v_fmac_f32 v89, s43, v79
  s_lshl_b32 s40, s84, 16
  s_and_b32 s41, s84, 0xffff0000
  s_lshl_b32 s42, s85, 16
  s_and_b32 s43, s85, 0xffff0000
  v_fmac_f32 v86, s40, v80
  v_fmac_f32 v87, s41, v80
  v_fmac_f32 v88, s42, v80
  v_fmac_f32 v89, s43, v80
  s_lshl_b32 s40, s86, 16
  s_and_b32 s41, s86, 0xffff0000
  s_lshl_b32 s42, s87, 16
  s_and_b32 s43, s87, 0xffff0000
  v_fmac_f32 v86, s40, v81
  v_fmac_f32 v87, s41, v81
  v_fmac_f32 v88, s42, v81
  v_fmac_f32 v89, s43, v81
  s_lshl_b32 s40, s88, 16
  s_and_b32 s41, s88, 0xffff0000
  s_lshl_b32 s42, s89, 16
  s_and_b32 s43, s89, 0xffff0000
  v_fmac_f32 v86, s40, v82
  v_fmac_f32 v87, s41, v82
  v_fmac_f32 v88, s42, v82
  v_fmac_f32 v89, s43, v82
  s_lshl_b32 s40, s90, 16
  s_and_b32 s41, s90, 0xffff0000
  s_lshl_b32 s42, s91, 16
  s_and_b32 s43, s91, 0xffff0000
  v_fmac_f32 v86, s40, v83
  v_fmac_f32 v87, s41, v83
  v_fmac_f32 v88, s42, v83
  v_fmac_f32 v89, s43, v83
  s_lshl_b32 s40, s92, 16
  s_and_b32 s41, s92, 0xffff0000
  s_lshl_b32 s42, s93, 16
  s_and_b32 s43, s93, 0xffff0000
  v_fmac_f32 v86, s40, v84
  v_fmac_f32 v87, s41, v84
  v_fmac_f32 v88, s42, v84
  v_fmac_f32 v89, s43, v84
  s_lshl_b32 s40, s94, 16
  s_and_b32 s41, s94, 0xffff0000
  s_lshl_b32 s42, s95, 16
  s_and_b32 s43, s95, 0xffff0000
  v_fmac_f32 v86, s40, v85
  v_fmac_f32 v87, s41, v85
  v_fmac_f32 v88, s42, v85
  v_fmac_f32 v89, s43, v85
  s_load_dwordx16 s[80:95], s[20:21], 0
  s_waitcnt lgkmcnt(0)
  s_lshl_b32 s40, s80, 16
  s_and_b32 s41, s80, 0xffff0000
  s_lshl_b32 s42, s81, 16
  s_and_b32 s43, s81, 0xffff0000
  v_mul_f32 v114, s40, v78
  v_mul_f32 v115, s41, v78
  v_mul_f32 v116, s42, v78
  v_mul_f32 v117, s43, v78
  s_lshl_b32 s40, s82, 16
  s_and_b32 s41, s82, 0xffff0000
  s_lshl_b32 s42, s83, 16
  s_and_b32 s43, s83, 0xffff0000
  v_fmac_f32 v114, s40, v79
  v_fmac_f32 v115, s41, v79
  v_fmac_f32 v116, s42, v79
  v_fmac_f32 v117, s43, v79
  s_lshl_b32 s40, s84, 16
  s_and_b32 s41, s84, 0xffff0000
  s_lshl_b32 s42, s85, 16
  s_and_b32 s43, s85, 0xffff0000
  v_fmac_f32 v114, s40, v80
  v_fmac_f32 v115, s41, v80
  v_fmac_f32 v116, s42, v80
  v_fmac_f32 v117, s43, v80
  s_lshl_b32 s40, s86, 16
  s_and_b32 s41, s86, 0xffff0000
  s_lshl_b32 s42, s87, 16
  s_and_b32 s43, s87, 0xffff0000
  v_fmac_f32 v114, s40, v81
  v_fmac_f32 v115, s41, v81
  v_fmac_f32 v116, s42, v81
  v_fmac_f32 v117, s43, v81
  s_lshl_b32 s40, s88, 16
  s_and_b32 s41, s88, 0xffff0000
  s_lshl_b32 s42, s89, 16
  s_and_b32 s43, s89, 0xffff0000
  v_fmac_f32 v114, s40, v82
  v_fmac_f32 v115, s41, v82
  v_fmac_f32 v116, s42, v82
  v_fmac_f32 v117, s43, v82
  s_lshl_b32 s40, s90, 16
  s_and_b32 s41, s90, 0xffff0000
  s_lshl_b32 s42, s91, 16
  s_and_b32 s43, s91, 0xffff0000
  v_fmac_f32 v114, s40, v83
  v_fmac_f32 v115, s41, v83
  v_fmac_f32 v116, s42, v83
  v_fmac_f32 v117, s43, v83
  s_lshl_b32 s40, s92, 16
  s_and_b32 s41, s92, 0xffff0000
  s_lshl_b32 s42, s93, 16
  s_and_b32 s43, s93, 0xffff0000
  v_fmac_f32 v114, s40, v84
  v_fmac_f32 v115, s41, v84
  v_fmac_f32 v116, s42, v84
  v_fmac_f32 v117, s43, v84
  s_lshl_b32 s40, s94, 16
  s_and_b32 s41, s94, 0xffff0000
  s_lshl_b32 s42, s95, 16
  s_and_b32 s43, s95, 0xffff0000
  v_fmac_f32 v114, s40, v85
  v_fmac_f32 v115, s41, v85
  v_fmac_f32 v116, s42, v85
  v_fmac_f32 v117, s43, v85
  s_load_dwordx8 s[80:87], s[24:25], 0
  s_load_dwordx8 s[88:95], s[26:27], 0
  s_waitcnt lgkmcnt(0)
  s_lshl_b32 s40, s88, 16
  s_lshl_b32 s41, s90, 16
  s_lshl_b32 s42, s92, 16
  s_lshl_b32 s43, s94, 16
  v_mul_f32 v78, s40, v86
  v_mul_f32 v79, s41, v87
  v_mul_f32 v80, s42, v88
  v_mul_f32 v81, s43, v89
  v_mul_f32 v78, v78, v114
  v_mul_f32 v79, v79, v114
  v_mul_f32 v80, v80, v114
  v_mul_f32 v81, v81, v114
  s_lshl_b32 s40, s80, 16
  s_and_b32 s41, s80, 0xffff0000
  s_lshl_b32 s42, s81, 16
  s_and_b32 s43, s81, 0xffff0000
  v_mul_f32 v98, s40, v78
  v_fmac_f32 v98, s41, v79
  v_fmac_f32 v98, s42, v80
  v_fmac_f32 v98, s43, v81
  s_lshl_b32 s40, s82, 16
  s_and_b32 s41, s82, 0xffff0000
  s_lshl_b32 s42, s83, 16
  s_and_b32 s43, s83, 0xffff0000
  v_mul_f32 v102, s40, v78
  v_fmac_f32 v102, s41, v79
  v_fmac_f32 v102, s42, v80
  v_fmac_f32 v102, s43, v81
  s_lshl_b32 s40, s84, 16
  s_and_b32 s41, s84, 0xffff0000
  s_lshl_b32 s42, s85, 16
  s_and_b32 s43, s85, 0xffff0000
  v_mul_f32 v106, s40, v78
  v_fmac_f32 v106, s41, v79
  v_fmac_f32 v106, s42, v80
  v_fmac_f32 v106, s43, v81
  s_lshl_b32 s40, s86, 16
  s_and_b32 s41, s86, 0xffff0000
  s_lshl_b32 s42, s87, 16
  s_and_b32 s43, s87, 0xffff0000
  v_mul_f32 v110, s40, v78
  v_fmac_f32 v110, s41, v79
  v_fmac_f32 v110, s42, v80
  v_fmac_f32 v110, s43, v81
  s_and_b32 s40, s88, 0xffff0000
  s_and_b32 s41, s90, 0xffff0000
  s_and_b32 s42, s92, 0xffff0000
  s_and_b32 s43, s94, 0xffff0000
  v_mul_f32 v78, s40, v86
  v_mul_f32 v79, s41, v87
  v_mul_f32 v80, s42, v88
  v_mul_f32 v81, s43, v89
  v_mul_f32 v78, v78, v115
  v_mul_f32 v79, v79, v115
  v_mul_f32 v80, v80, v115
  v_mul_f32 v81, v81, v115
  s_lshl_b32 s40, s80, 16
  s_and_b32 s41, s80, 0xffff0000
  s_lshl_b32 s42, s81, 16
  s_and_b32 s43, s81, 0xffff0000
  v_mul_f32 v99, s40, v78
  v_fmac_f32 v99, s41, v79
  v_fmac_f32 v99, s42, v80
  v_fmac_f32 v99, s43, v81
  s_lshl_b32 s40, s82, 16
  s_and_b32 s41, s82, 0xffff0000
  s_lshl_b32 s42, s83, 16
  s_and_b32 s43, s83, 0xffff0000
  v_mul_f32 v103, s40, v78
  v_fmac_f32 v103, s41, v79
  v_fmac_f32 v103, s42, v80
  v_fmac_f32 v103, s43, v81
  s_lshl_b32 s40, s84, 16
  s_and_b32 s41, s84, 0xffff0000
  s_lshl_b32 s42, s85, 16
  s_and_b32 s43, s85, 0xffff0000
  v_mul_f32 v107, s40, v78
  v_fmac_f32 v107, s41, v79
  v_fmac_f32 v107, s42, v80
  v_fmac_f32 v107, s43, v81
  s_lshl_b32 s40, s86, 16
  s_and_b32 s41, s86, 0xffff0000
  s_lshl_b32 s42, s87, 16
  s_and_b32 s43, s87, 0xffff0000
  v_mul_f32 v111, s40, v78
  v_fmac_f32 v111, s41, v79
  v_fmac_f32 v111, s42, v80
  v_fmac_f32 v111, s43, v81
  s_lshl_b32 s40, s89, 16
  s_lshl_b32 s41, s91, 16
  s_lshl_b32 s42, s93, 16
  s_lshl_b32 s43, s95, 16
  v_mul_f32 v78, s40, v86
  v_mul_f32 v79, s41, v87
  v_mul_f32 v80, s42, v88
  v_mul_f32 v81, s43, v89
  v_mul_f32 v78, v78, v116
  v_mul_f32 v79, v79, v116
  v_mul_f32 v80, v80, v116
  v_mul_f32 v81, v81, v116
  s_lshl_b32 s40, s80, 16
  s_and_b32 s41, s80, 0xffff0000
  s_lshl_b32 s42, s81, 16
  s_and_b32 s43, s81, 0xffff0000
  v_mul_f32 v100, s40, v78
  v_fmac_f32 v100, s41, v79
  v_fmac_f32 v100, s42, v80
  v_fmac_f32 v100, s43, v81
  s_lshl_b32 s40, s82, 16
  s_and_b32 s41, s82, 0xffff0000
  s_lshl_b32 s42, s83, 16
  s_and_b32 s43, s83, 0xffff0000
  v_mul_f32 v104, s40, v78
  v_fmac_f32 v104, s41, v79
  v_fmac_f32 v104, s42, v80
  v_fmac_f32 v104, s43, v81
  s_lshl_b32 s40, s84, 16
  s_and_b32 s41, s84, 0xffff0000
  s_lshl_b32 s42, s85, 16
  s_and_b32 s43, s85, 0xffff0000
  v_mul_f32 v108, s40, v78
  v_fmac_f32 v108, s41, v79
  v_fmac_f32 v108, s42, v80
  v_fmac_f32 v108, s43, v81
  s_lshl_b32 s40, s86, 16
  s_and_b32 s41, s86, 0xffff0000
  s_lshl_b32 s42, s87, 16
  s_and_b32 s43, s87, 0xffff0000
  v_mul_f32 v112, s40, v78
  v_fmac_f32 v112, s41, v79
  v_fmac_f32 v112, s42, v80
  v_fmac_f32 v112, s43, v81
  s_and_b32 s40, s89, 0xffff0000
  s_and_b32 s41, s91, 0xffff0000
  s_and_b32 s42, s93, 0xffff0000
  s_and_b32 s43, s95, 0xffff0000
  v_mul_f32 v78, s40, v86
  v_mul_f32 v79, s41, v87
  v_mul_f32 v80, s42, v88
  v_mul_f32 v81, s43, v89
  v_mul_f32 v78, v78, v117
  v_mul_f32 v79, v79, v117
  v_mul_f32 v80, v80, v117
  v_mul_f32 v81, v81, v117
  s_lshl_b32 s40, s80, 16
  s_and_b32 s41, s80, 0xffff0000
  s_lshl_b32 s42, s81, 16
  s_and_b32 s43, s81, 0xffff0000
  v_mul_f32 v101, s40, v78
  v_fmac_f32 v101, s41, v79
  v_fmac_f32 v101, s42, v80
  v_fmac_f32 v101, s43, v81
  s_lshl_b32 s40, s82, 16
  s_and_b32 s41, s82, 0xffff0000
  s_lshl_b32 s42, s83, 16
  s_and_b32 s43, s83, 0xffff0000
  v_mul_f32 v105, s40, v78
  v_fmac_f32 v105, s41, v79
  v_fmac_f32 v105, s42, v80
  v_fmac_f32 v105, s43, v81
  s_lshl_b32 s40, s84, 16
  s_and_b32 s41, s84, 0xffff0000
  s_lshl_b32 s42, s85, 16
  s_and_b32 s43, s85, 0xffff0000
  v_mul_f32 v109, s40, v78
  v_fmac_f32 v109, s41, v79
  v_fmac_f32 v109, s42, v80
  v_fmac_f32 v109, s43, v81
  s_lshl_b32 s40, s86, 16
  s_and_b32 s41, s86, 0xffff0000
  s_lshl_b32 s42, s87, 16
  s_and_b32 s43, s87, 0xffff0000
  v_mul_f32 v113, s40, v78
  v_fmac_f32 v113, s41, v79
  v_fmac_f32 v113, s42, v80
  v_fmac_f32 v113, s43, v81
L_nopre:
  s_cmp_lt_u32 s30, 4
  s_cbranch_scc1 L_accum
  s_cmp_ge_u32 s30, 8
  s_cbranch_scc1 L_inter
L_gath:
  s_or_b64 exec, s[44:45], 1
  buffer_load_dwordx2 v[44:45], v44, s[4:7], 0 offen
  s_or_b64 exec, s[46:47], 1
  buffer_load_dwordx2 v[46:47], v46, s[4:7], 0 offen
  s_or_b64 exec, s[48:49], 1
  buffer_load_dwordx2 v[48:49], v48, s[4:7], 0 offen
  s_or_b64 exec, s[50:51], 1
  buffer_load_dwordx2 v[50:51], v50, s[4:7], 0 offen
  s_or_b64 exec, s[52:53], 1
  buffer_load_dwordx2 v[52:53], v52, s[4:7], 0 offen
  s_or_b64 exec, s[54:55], 1
  buffer_load_dwordx2 v[54:55], v54, s[4:7], 0 offen
  s_or_b64 exec, s[56:57], 1
  buffer_load_dwordx2 v[56:57], v56, s[4:7], 0 offen
  s_or_b64 exec, s[58:59], 1
  buffer_load_dwordx2 v[58:59], v58, s[4:7], 0 offen
  s_or_b64 exec, s[60:61], 1
  buffer_load_dwordx2 v[60:61], v60, s[4:7], 0 offen
  s_or_b64 exec, s[62:63], 1
  buffer_load_dwordx2 v[62:63], v62, s[4:7], 0 offen
  s_or_b64 exec, s[64:65], 1
  buffer_load_dwordx2 v[64:65], v64, s[4:7], 0 offen
  s_or_b64 exec, s[66:67], 1
  buffer_load_dwordx2 v[66:67], v66, s[4:7], 0 offen
  s_or_b64 exec, s[68:69], 1
  buffer_load_dwordx2 v[68:69], v68, s[4:7], 0 offen
  s_or_b64 exec, s[70:71], 1
  buffer_load_dwordx2 v[70:71], v70, s[4:7], 0 offen
  s_or_b64 exec, s[72:73], 1
  buffer_load_dwordx2 v[72:73], v72, s[4:7], 0 offen
  s_or_b64 exec, s[74:75], 1
  buffer_load_dwordx2 v[74:75], v74, s[4:7], 0 offen
  s_mov_b64 exec, -1
  s_cmp_ge_u32 s30, 4
  s_cbranch_scc1 L_accum
  v_mov_b32 v118, 0
  v_mov_b32 v119, 0
  ds_write_b64 v7, v[118:119] offset:0
  ds_write_b64 v7, v[118:119] offset:512
  ds_write_b64 v7, v[118:119] offset:1024
  ds_write_b64 v7, v[118:119] offset:1536
  ds_write_b64 v7, v[118:119] offset:2048
  ds_write_b64 v7, v[118:119] offset:2560
  ds_write_b64 v7, v[118:119] offset:3072
  ds_write_b64 v7, v[118:119] offset:3584
  ds_write_b64 v7, v[118:119] offset:4096
  ds_write_b64 v7, v[118:119] offset:4608
  ds_write_b64 v7, v[118:119] offset:5120
  ds_write_b64 v7, v[118:119] offset:5632
  ds_write_b64 v7, v[118:119] offset:6144
  ds_write_b64 v7, v[118:119] offset:6656
  ds_write_b64 v7, v[118:119] offset:7168
  ds_write_b64 v7, v[118:119] offset:7680
  s_waitcnt lgkmcnt(0)
  s_barrier
  s_branch L_side
L_accum:
  s_waitcnt vmcnt(15)
  s_mov_b64 exec, s[44:45]
  s_cbranch_execz L_skipa0
  v_lshlrev_b32 v78, 16, v44
  v_and_b32 v79, 0xffff0000, v44
  v_lshlrev_b32 v80, 16, v45
  v_and_b32 v81, 0xffff0000, v45
  v_and_b32 v86, 0xffff0000, v11
  v_cmp_gt_i32 vcc, 0, v10
  v_pk_mul_f32 v[78:79], v[78:79], v[86:87] op_sel_hi:[1,0]
  v_pk_mul_f32 v[80:81], v[80:81], v[86:87] op_sel_hi:[1,0]
  v_cvt_pk_bf16_f32 v88, v78, v79
  v_cvt_pk_bf16_f32 v89, v80, v81
  s_cbranch_vccnz L_ovfba0
L_backba0:
  ds_write_b64 v10, v[88:89] offset:25664
L_skipa0:
  s_waitcnt vmcnt(14)
  s_mov_b64 exec, s[46:47]
  s_cbranch_execz L_skipa1
  v_lshlrev_b32 v78, 16, v46
  v_and_b32 v79, 0xffff0000, v46
  v_lshlrev_b32 v80, 16, v47
  v_and_b32 v81, 0xffff0000, v47
  v_and_b32 v86, 0xffff0000, v13
  v_cmp_gt_i32 vcc, 0, v12
  v_pk_mul_f32 v[78:79], v[78:79], v[86:87] op_sel_hi:[1,0]
  v_pk_mul_f32 v[80:81], v[80:81], v[86:87] op_sel_hi:[1,0]
  v_cvt_pk_bf16_f32 v90, v78, v79
  v_cvt_pk_bf16_f32 v91, v80, v81
  s_cbranch_vccnz L_ovfba1
L_backba1:
  ds_write_b64 v12, v[90:91] offset:25664
L_skipa1:
  s_waitcnt vmcnt(13)
  s_mov_b64 exec, s[48:49]
  s_cbranch_execz L_skipa2
  v_lshlrev_b32 v78, 16, v48
  v_and_b32 v79, 0xffff0000, v48
  v_lshlrev_b32 v80, 16, v49
  v_and_b32 v81, 0xffff0000, v49
  v_and_b32 v86, 0xffff0000, v15
  v_cmp_gt_i32 vcc, 0, v14
  v_pk_mul_f32 v[78:79], v[78:79], v[86:87] op_sel_hi:[1,0]
  v_pk_mul_f32 v[80:81], v[80:81], v[86:87] op_sel_hi:[1,0]
  v_cvt_pk_bf16_f32 v88, v78, v79
  v_cvt_pk_bf16_f32 v89, v80, v81
  s_cbranch_vccnz L_ovfba2
L_backba2:
  ds_write_b64 v14, v[88:89] offset:25664
L_skipa2:
  s_waitcnt vmcnt(12)
  s_mov_b64 exec, s[50:51]
  s_cbranch_execz L_skipa3
  v_lshlrev_b32 v78, 16, v50
  v_and_b32 v79, 0xffff0000, v50
  v_lshlrev_b32 v80, 16, v51
  v_and_b32 v81, 0xffff0000, v51
  v_and_b32 v86, 0xffff0000, v17
  v_cmp_gt_i32 vcc, 0, v16
  v_pk_mul_f32 v[78:79], v[78:79], v[86:87] op_sel_hi:[1,0]
  v_pk_mul_f32 v[80:81], v[80:81], v[86:87] op_sel_hi:[1,0]
  v_cvt_pk_bf16_f32 v90, v78, v79
  v_cvt_pk_bf16_f32 v91, v80, v81
  s_cbranch_vccnz L_ovfba3
L_backba3:
  ds_write_b64 v16, v[90:91] offset:25664
L_skipa3:
  s_waitcnt vmcnt(11)
  s_mov_b64 exec, s[52:53]
  s_cbranch_execz L_skipa4
  v_lshlrev_b32 v78, 16, v52
  v_and_b32 v79, 0xffff0000, v52
  v_lshlrev_b32 v80, 16, v53
  v_and_b32 v81, 0xffff0000, v53
  v_and_b32 v86, 0xffff0000, v19
  v_cmp_gt_i32 vcc, 0, v18
  v_pk_mul_f32 v[78:79], v[78:79], v[86:87] op_sel_hi:[1,0]
  v_pk_mul_f32 v[80:81], v[80:81], v[86:87] op_sel_hi:[1,0]
  v_cvt_pk_bf16_f32 v88, v78, v79
  v_cvt_pk_bf16_f32 v89, v80, v81
  s_cbranch_vccnz L_ovfba4
L_backba4:
  ds_write_b64 v18, v[88:89] offset:25664
L_skipa4:
  s_waitcnt vmcnt(10)
  s_mov_b64 exec, s[54:55]
  s_cbranch_execz L_skipa5
  v_lshlrev_b32 v78, 16, v54
  v_and_b32 v79, 0xffff0000, v54
  v_lshlrev_b32 v80, 16, v55
  v_and_b32 v81, 0xffff0000, v55
  v_and_b32 v86, 0xffff0000, v21
  v_cmp_gt_i32 vcc, 0, v20
  v_pk_mul_f32 v[78:79], v[78:79], v[86:87] op_sel_hi:[1,0]
  v_pk_mul_f32 v[80:81], v[80:81], v[86:87] op_sel_hi:[1,0]
  v_cvt_pk_bf16_f32 v90, v78, v79
  v_cvt_pk_bf16_f32 v91, v80, v81
  s_cbranch_vccnz L_ovfba5
L_backba5:
  ds_write_b64 v20, v[90:91] offset:25664
L_skipa5:
  s_waitcnt vmcnt(9)
  s_mov_b64 exec, s[56:57]
  s_cbranch_execz L_skipa6
  v_lshlrev_b32 v78, 16, v56
  v_and_b32 v79, 0xffff0000, v56
  v_lshlrev_b32 v80, 16, v57
  v_and_b32 v81, 0xffff0000, v57
  v_and_b32 v86, 0xffff0000, v23
  v_cmp_gt_i32 vcc, 0, v22
  v_pk_mul_f32 v[78:79], v[78:79], v[86:87] op_sel_hi:[1,0]
  v_pk_mul_f32 v[80:81], v[80:81], v[86:87] op_sel_hi:[1,0]
  v_cvt_pk_bf16_f32 v88, v78, v79
  v_cvt_pk_bf16_f32 v89, v80, v81
  s_cbranch_vccnz L_ovfba6
L_backba6:
  ds_write_b64 v22, v[88:89] offset:25664
L_skipa6:
  s_waitcnt vmcnt(8)
  s_mov_b64 exec, s[58:59]
  s_cbranch_execz L_skipa7
  v_lshlrev_b32 v78, 16, v58
  v_and_b32 v79, 0xffff0000, v58
  v_lshlrev_b32 v80, 16, v59
  v_and_b32 v81, 0xffff0000, v59
  v_and_b32 v86, 0xffff0000, v25
  v_cmp_gt_i32 vcc, 0, v24
  v_pk_mul_f32 v[78:79], v[78:79], v[86:87] op_sel_hi:[1,0]
  v_pk_mul_f32 v[80:81], v[80:81], v[86:87] op_sel_hi:[1,0]
  v_cvt_pk_bf16_f32 v90, v78, v79
  v_cvt_pk_bf16_f32 v91, v80, v81
  s_cbranch_vccnz L_ovfba7
L_backba7:
  ds_write_b64 v24, v[90:91] offset:25664
L_skipa7:
  s_waitcnt vmcnt(7)
  s_mov_b64 exec, s[60:61]
  s_cbranch_execz L_skipa8
  v_lshlrev_b32 v78, 16, v60
  v_and_b32 v79, 0xffff0000, v60
  v_lshlrev_b32 v80, 16, v61
  v_and_b32 v81, 0xffff0000, v61
  v_and_b32 v86, 0xffff0000, v27
  v_cmp_gt_i32 vcc, 0, v26
  v_pk_mul_f32 v[78:79], v[78:79], v[86:87] op_sel_hi:[1,0]
  v_pk_mul_f32 v[80:81], v[80:81], v[86:87] op_sel_hi:[1,0]
  v_cvt_pk_bf16_f32 v88, v78, v79
  v_cvt_pk_bf16_f32 v89, v80, v81
  s_cbranch_vccnz L_ovfba8
L_backba8:
  ds_write_b64 v26, v[88:89] offset:25664
L_skipa8:
  s_waitcnt vmcnt(6)
  s_mov_b64 exec, s[62:63]
  s_cbranch_execz L_skipa9
  v_lshlrev_b32 v78, 16, v62
  v_and_b32 v79, 0xffff0000, v62
  v_lshlrev_b32 v80, 16, v63
  v_and_b32 v81, 0xffff0000, v63
  v_and_b32 v86, 0xffff0000, v29
  v_cmp_gt_i32 vcc, 0, v28
  v_pk_mul_f32 v[78:79], v[78:79], v[86:87] op_sel_hi:[1,0]
  v_pk_mul_f32 v[80:81], v[80:81], v[86:87] op_sel_hi:[1,0]
  v_cvt_pk_bf16_f32 v90, v78, v79
  v_cvt_pk_bf16_f32 v91, v80, v81
  s_cbranch_vccnz L_ovfba9
L_backba9:
  ds_write_b64 v28, v[90:91] offset:25664
L_skipa9:
  s_waitcnt vmcnt(5)
  s_mov_b64 exec, s[64:65]
  s_cbranch_execz L_skipa10
  v_lshlrev_b32 v78, 16, v64
  v_and_b32 v79, 0xffff0000, v64
  v_lshlrev_b32 v80, 16, v65
  v_and_b32 v81, 0xffff0000, v65
  v_and_b32 v86, 0xffff0000, v31
  v_cmp_gt_i32 vcc, 0, v30
  v_pk_mul_f32 v[78:79], v[78:79], v[86:87] op_sel_hi:[1,0]
  v_pk_mul_f32 v[80:81], v[80:81], v[86:87] op_sel_hi:[1,0]
  v_cvt_pk_bf16_f32 v88, v78, v79
  v_cvt_pk_bf16_f32 v89, v80, v81
  s_cbranch_vccnz L_ovfba10
L_backba10:
  ds_write_b64 v30, v[88:89] offset:25664
L_skipa10:
  s_waitcnt vmcnt(4)
  s_mov_b64 exec, s[66:67]
  s_cbranch_execz L_skipa11
  v_lshlrev_b32 v78, 16, v66
  v_and_b32 v79, 0xffff0000, v66
  v_lshlrev_b32 v80, 16, v67
  v_and_b32 v81, 0xffff0000, v67
  v_and_b32 v86, 0xffff0000, v33
  v_cmp_gt_i32 vcc, 0, v32
  v_pk_mul_f32 v[78:79], v[78:79], v[86:87] op_sel_hi:[1,0]
  v_pk_mul_f32 v[80:81], v[80:81], v[86:87] op_sel_hi:[1,0]
  v_cvt_pk_bf16_f32 v90, v78, v79
  v_cvt_pk_bf16_f32 v91, v80, v81
  s_cbranch_vccnz L_ovfba11
L_backba11:
  ds_write_b64 v32, v[90:91] offset:25664
L_skipa11:
  s_waitcnt vmcnt(3)
  s_mov_b64 exec, s[68:69]
  s_cbranch_execz L_skipa12
  v_lshlrev_b32 v78, 16, v68
  v_and_b32 v79, 0xffff0000, v68
  v_lshlrev_b32 v80, 16, v69
  v_and_b32 v81, 0xffff0000, v69
  v_and_b32 v86, 0xffff0000, v35
  v_cmp_gt_i32 vcc, 0, v34
  v_pk_mul_f32 v[78:79], v[78:79], v[86:87] op_sel_hi:[1,0]
  v_pk_mul_f32 v[80:81], v[80:81], v[86:87] op_sel_hi:[1,0]
  v_cvt_pk_bf16_f32 v88, v78, v79
  v_cvt_pk_bf16_f32 v89, v80, v81
  s_cbranch_vccnz L_ovfba12
L_backba12:
  ds_write_b64 v34, v[88:89] offset:25664
L_skipa12:
  s_waitcnt vmcnt(2)
  s_mov_b64 exec, s[70:71]
  s_cbranch_execz L_skipa13
  v_lshlrev_b32 v78, 16, v70
  v_and_b32 v79, 0xffff0000, v70
  v_lshlrev_b32 v80, 16, v71
  v_and_b32 v81, 0xffff0000, v71
  v_and_b32 v86, 0xffff0000, v37
  v_cmp_gt_i32 vcc, 0, v36
  v_pk_mul_f32 v[78:79], v[78:79], v[86:87] op_sel_hi:[1,0]
  v_pk_mul_f32 v[80:81], v[80:81], v[86:87] op_sel_hi:[1,0]
  v_cvt_pk_bf16_f32 v90, v78, v79
  v_cvt_pk_bf16_f32 v91, v80, v81
  s_cbranch_vccnz L_ovfba13
L_backba13:
  ds_write_b64 v36, v[90:91] offset:25664
L_skipa13:
  s_waitcnt vmcnt(1)
  s_mov_b64 exec, s[72:73]
  s_cbranch_execz L_skipa14
  v_lshlrev_b32 v78, 16, v72
  v_and_b32 v79, 0xffff0000, v72
  v_lshlrev_b32 v80, 16, v73
  v_and_b32 v81, 0xffff0000, v73
  v_and_b32 v86, 0xffff0000, v39
  v_cmp_gt_i32 vcc, 0, v38
  v_pk_mul_f32 v[78:79], v[78:79], v[86:87] op_sel_hi:[1,0]
  v_pk_mul_f32 v[80:81], v[80:81], v[86:87] op_sel_hi:[1,0]
  v_cvt_pk_bf16_f32 v88, v78, v79
  v_cvt_pk_bf16_f32 v89, v80, v81
  s_cbranch_vccnz L_ovfba14
L_backba14:
  ds_write_b64 v38, v[88:89] offset:25664
L_skipa14:
  s_waitcnt vmcnt(0)
  s_mov_b64 exec, s[74:75]
  s_cbranch_execz L_skipa15
  v_lshlrev_b32 v78, 16, v74
  v_and_b32 v79, 0xffff0000, v74
  v_lshlrev_b32 v80, 16, v75
  v_and_b32 v81, 0xffff0000, v75
  v_and_b32 v86, 0xffff0000, v41
  v_cmp_gt_i32 vcc, 0, v40
  v_pk_mul_f32 v[78:79], v[78:79], v[86:87] op_sel_hi:[1,0]
  v_pk_mul_f32 v[80:81], v[80:81], v[86:87] op_sel_hi:[1,0]
  v_cvt_pk_bf16_f32 v90, v78, v79
  v_cvt_pk_bf16_f32 v91, v80, v81
  s_cbranch_vccnz L_ovfba15
L_backba15:
  ds_write_b64 v40, v[90:91] offset:25664
L_skipa15:
  s_mov_b64 exec, -1
  s_branch L_left
L_inter:
  s_or_b64 exec, s[44:45], 1
  buffer_load_dwordx2 v[44:45], v44, s[4:7], 0 offen
  s_or_b64 exec, s[46:47], 1
  buffer_load_dwordx2 v[46:47], v46, s[4:7], 0 offen
  s_or_b64 exec, s[48:49], 1
  buffer_load_dwordx2 v[48:49], v48, s[4:7], 0 offen
  s_or_b64 exec, s[50:51], 1
  buffer_load_dwordx2 v[50:51], v50, s[4:7], 0 offen
  s_or_b64 exec, s[52:53], 1
  buffer_load_dwordx2 v[52:53], v52, s[4:7], 0 offen
  s_waitcnt vmcnt(4)
  s_mov_b64 exec, s[44:45]
  s_cbranch_execz L_skipb0
  v_lshlrev_b32 v78, 16, v44
  v_and_b32 v79, 0xffff0000, v44
  v_lshlrev_b32 v80, 16, v45
  v_and_b32 v81, 0xffff0000, v45
  v_and_b32 v86, 0xffff0000, v11
  v_cmp_gt_i32 vcc, 0, v10
  v_pk_mul_f32 v[78:79], v[78:79], v[86:87] op_sel_hi:[1,0]
  v_pk_mul_f32 v[80:81], v[80:81], v[86:87] op_sel_hi:[1,0]
  v_cvt_pk_bf16_f32 v88, v78, v79
  v_cvt_pk_bf16_f32 v89, v80, v81
  s_cbranch_vccnz L_ovfbb0
L_backbb0:
  ds_write_b64 v10, v[88:89] offset:25664
L_skipb0:
  s_or_b64 exec, s[54:55], 1
  buffer_load_dwordx2 v[54:55], v54, s[4:7], 0 offen
  s_waitcnt vmcnt(4)
  s_mov_b64 exec, s[46:47]
  s_cbranch_execz L_skipb1
  v_lshlrev_b32 v78, 16, v46
  v_and_b32 v79, 0xffff0000, v46
  v_lshlrev_b32 v80, 16, v47
  v_and_b32 v81, 0xffff0000, v47
  v_and_b32 v86, 0xffff0000, v13
  v_cmp_gt_i32 vcc, 0, v12
  v_pk_mul_f32 v[78:79], v[78:79], v[86:87] op_sel_hi:[1,0]
  v_pk_mul_f32 v[80:81], v[80:81], v[86:87] op_sel_hi:[1,0]
  v_cvt_pk_bf16_f32 v90, v78, v79
  v_cvt_pk_bf16_f32 v91, v80, v81
  s_cbranch_vccnz L_ovfbb1
L_backbb1:
  ds_write_b64 v12, v[90:91] offset:25664
L_skipb1:
  s_or_b64 exec, s[56:57], 1
  buffer_load_dwordx2 v[56:57], v56, s[4:7], 0 offen
  s_waitcnt vmcnt(4)
  s_mov_b64 exec, s[48:49]
  s_cbranch_execz L_skipb2
  v_lshlrev_b32 v78, 16, v48
  v_and_b32 v79, 0xffff0000, v48
  v_lshlrev_b32 v80, 16, v49
  v_and_b32 v81, 0xffff0000, v49
  v_and_b32 v86, 0xffff0000, v15
  v_cmp_gt_i32 vcc, 0, v14
  v_pk_mul_f32 v[78:79], v[78:79], v[86:87] op_sel_hi:[1,0]
  v_pk_mul_f32 v[80:81], v[80:81], v[86:87] op_sel_hi:[1,0]
  v_cvt_pk_bf16_f32 v88, v78, v79
  v_cvt_pk_bf16_f32 v89, v80, v81
  s_cbranch_vccnz L_ovfbb2
L_backbb2:
  ds_write_b64 v14, v[88:89] offset:25664
L_skipb2:
  s_or_b64 exec, s[58:59], 1
  buffer_load_dwordx2 v[58:59], v58, s[4:7], 0 offen
  s_waitcnt vmcnt(4)
  s_mov_b64 exec, s[50:51]
  s_cbranch_execz L_skipb3
  v_lshlrev_b32 v78, 16, v50
  v_and_b32 v79, 0xffff0000, v50
  v_lshlrev_b32 v80, 16, v51
  v_and_b32 v81, 0xffff0000, v51
  v_and_b32 v86, 0xffff0000, v17
  v_cmp_gt_i32 vcc, 0, v16
  v_pk_mul_f32 v[78:79], v[78:79], v[86:87] op_sel_hi:[1,0]
  v_pk_mul_f32 v[80:81], v[80:81], v[86:87] op_sel_hi:[1,0]
  v_cvt_pk_bf16_f32 v90, v78, v79
  v_cvt_pk_bf16_f32 v91, v80, v81
  s_cbranch_vccnz L_ovfbb3
L_backbb3:
  ds_write_b64 v16, v[90:91] offset:25664
L_skipb3:
  s_or_b64 exec, s[60:61], 1
  buffer_load_dwordx2 v[60:61], v60, s[4:7], 0 offen
  s_waitcnt vmcnt(4)
  s_mov_b64 exec, s[52:53]
  s_cbranch_execz L_skipb4
  v_lshlrev_b32 v78, 16, v52
  v_and_b32 v79, 0xffff0000, v52
  v_lshlrev_b32 v80, 16, v53
  v_and_b32 v81, 0xffff0000, v53
  v_and_b32 v86, 0xffff0000, v19
  v_cmp_gt_i32 vcc, 0, v18
  v_pk_mul_f32 v[78:79], v[78:79], v[86:87] op_sel_hi:[1,0]
  v_pk_mul_f32 v[80:81], v[80:81], v[86:87] op_sel_hi:[1,0]
  v_cvt_pk_bf16_f32 v88, v78, v79
  v_cvt_pk_bf16_f32 v89, v80, v81
  s_cbranch_vccnz L_ovfbb4
L_backbb4:
  ds_write_b64 v18, v[88:89] offset:25664
L_skipb4:
  s_or_b64 exec, s[62:63], 1
  buffer_load_dwordx2 v[62:63], v62, s[4:7], 0 offen
  s_waitcnt vmcnt(4)
  s_mov_b64 exec, s[54:55]
  s_cbranch_execz L_skipb5
  v_lshlrev_b32 v78, 16, v54
  v_and_b32 v79, 0xffff0000, v54
  v_lshlrev_b32 v80, 16, v55
  v_and_b32 v81, 0xffff0000, v55
  v_and_b32 v86, 0xffff0000, v21
  v_cmp_gt_i32 vcc, 0, v20
  v_pk_mul_f32 v[78:79], v[78:79], v[86:87] op_sel_hi:[1,0]
  v_pk_mul_f32 v[80:81], v[80:81], v[86:87] op_sel_hi:[1,0]
  v_cvt_pk_bf16_f32 v90, v78, v79
  v_cvt_pk_bf16_f32 v91, v80, v81
  s_cbranch_vccnz L_ovfbb5
L_backbb5:
  ds_write_b64 v20, v[90:91] offset:25664
L_skipb5:
  s_or_b64 exec, s[64:65], 1
  buffer_load_dwordx2 v[64:65], v64, s[4:7], 0 offen
  s_waitcnt vmcnt(4)
  s_mov_b64 exec, s[56:57]
  s_cbranch_execz L_skipb6
  v_lshlrev_b32 v78, 16, v56
  v_and_b32 v79, 0xffff0000, v56
  v_lshlrev_b32 v80, 16, v57
  v_and_b32 v81, 0xffff0000, v57
  v_and_b32 v86, 0xffff0000, v23
  v_cmp_gt_i32 vcc, 0, v22
  v_pk_mul_f32 v[78:79], v[78:79], v[86:87] op_sel_hi:[1,0]
  v_pk_mul_f32 v[80:81], v[80:81], v[86:87] op_sel_hi:[1,0]
  v_cvt_pk_bf16_f32 v88, v78, v79
  v_cvt_pk_bf16_f32 v89, v80, v81
  s_cbranch_vccnz L_ovfbb6
L_backbb6:
  ds_write_b64 v22, v[88:89] offset:25664
L_skipb6:
  s_or_b64 exec, s[66:67], 1
  buffer_load_dwordx2 v[66:67], v66, s[4:7], 0 offen
  s_waitcnt vmcnt(4)
  s_mov_b64 exec, s[58:59]
  s_cbranch_execz L_skipb7
  v_lshlrev_b32 v78, 16, v58
  v_and_b32 v79, 0xffff0000, v58
  v_lshlrev_b32 v80, 16, v59
  v_and_b32 v81, 0xffff0000, v59
  v_and_b32 v86, 0xffff0000, v25
  v_cmp_gt_i32 vcc, 0, v24
  v_pk_mul_f32 v[78:79], v[78:79], v[86:87] op_sel_hi:[1,0]
  v_pk_mul_f32 v[80:81], v[80:81], v[86:87] op_sel_hi:[1,0]
  v_cvt_pk_bf16_f32 v90, v78, v79
  v_cvt_pk_bf16_f32 v91, v80, v81
  s_cbranch_vccnz L_ovfbb7
L_backbb7:
  ds_write_b64 v24, v[90:91] offset:25664
L_skipb7:
  s_or_b64 exec, s[68:69], 1
  buffer_load_dwordx2 v[68:69], v68, s[4:7], 0 offen
  s_waitcnt vmcnt(4)
  s_mov_b64 exec, s[60:61]
  s_cbranch_execz L_skipb8
  v_lshlrev_b32 v78, 16, v60
  v_and_b32 v79, 0xffff0000, v60
  v_lshlrev_b32 v80, 16, v61
  v_and_b32 v81, 0xffff0000, v61
  v_and_b32 v86, 0xffff0000, v27
  v_cmp_gt_i32 vcc, 0, v26
  v_pk_mul_f32 v[78:79], v[78:79], v[86:87] op_sel_hi:[1,0]
  v_pk_mul_f32 v[80:81], v[80:81], v[86:87] op_sel_hi:[1,0]
  v_cvt_pk_bf16_f32 v88, v78, v79
  v_cvt_pk_bf16_f32 v89, v80, v81
  s_cbranch_vccnz L_ovfbb8
L_backbb8:
  ds_write_b64 v26, v[88:89] offset:25664
L_skipb8:
  s_or_b64 exec, s[70:71], 1
  buffer_load_dwordx2 v[70:71], v70, s[4:7], 0 offen
  s_waitcnt vmcnt(4)
  s_mov_b64 exec, s[62:63]
  s_cbranch_execz L_skipb9
  v_lshlrev_b32 v78, 16, v62
  v_and_b32 v79, 0xffff0000, v62
  v_lshlrev_b32 v80, 16, v63
  v_and_b32 v81, 0xffff0000, v63
  v_and_b32 v86, 0xffff0000, v29
  v_cmp_gt_i32 vcc, 0, v28
  v_pk_mul_f32 v[78:79], v[78:79], v[86:87] op_sel_hi:[1,0]
  v_pk_mul_f32 v[80:81], v[80:81], v[86:87] op_sel_hi:[1,0]
  v_cvt_pk_bf16_f32 v90, v78, v79
  v_cvt_pk_bf16_f32 v91, v80, v81
  s_cbranch_vccnz L_ovfbb9
L_backbb9:
  ds_write_b64 v28, v[90:91] offset:25664
L_skipb9:
  s_or_b64 exec, s[72:73], 1
  buffer_load_dwordx2 v[72:73], v72, s[4:7], 0 offen
  s_waitcnt vmcnt(4)
  s_mov_b64 exec, s[64:65]
  s_cbranch_execz L_skipb10
  v_lshlrev_b32 v78, 16, v64
  v_and_b32 v79, 0xffff0000, v64
  v_lshlrev_b32 v80, 16, v65
  v_and_b32 v81, 0xffff0000, v65
  v_and_b32 v86, 0xffff0000, v31
  v_cmp_gt_i32 vcc, 0, v30
  v_pk_mul_f32 v[78:79], v[78:79], v[86:87] op_sel_hi:[1,0]
  v_pk_mul_f32 v[80:81], v[80:81], v[86:87] op_sel_hi:[1,0]
  v_cvt_pk_bf16_f32 v88, v78, v79
  v_cvt_pk_bf16_f32 v89, v80, v81
  s_cbranch_vccnz L_ovfbb10
L_backbb10:
  ds_write_b64 v30, v[88:89] offset:25664
L_skipb10:
  s_or_b64 exec, s[74:75], 1
  buffer_load_dwordx2 v[74:75], v74, s[4:7], 0 offen
  s_waitcnt vmcnt(4)
  s_mov_b64 exec, s[66:67]
  s_cbranch_execz L_skipb11
  v_lshlrev_b32 v78, 16, v66
  v_and_b32 v79, 0xffff0000, v66
  v_lshlrev_b32 v80, 16, v67
  v_and_b32 v81, 0xffff0000, v67
  v_and_b32 v86, 0xffff0000, v33
  v_cmp_gt_i32 vcc, 0, v32
  v_pk_mul_f32 v[78:79], v[78:79], v[86:87] op_sel_hi:[1,0]
  v_pk_mul_f32 v[80:81], v[80:81], v[86:87] op_sel_hi:[1,0]
  v_cvt_pk_bf16_f32 v90, v78, v79
  v_cvt_pk_bf16_f32 v91, v80, v81
  s_cbranch_vccnz L_ovfbb11
L_backbb11:
  ds_write_b64 v32, v[90:91] offset:25664
L_skipb11:
  s_waitcnt vmcnt(3)
  s_mov_b64 exec, s[68:69]
  s_cbranch_execz L_skipb12
  v_lshlrev_b32 v78, 16, v68
  v_and_b32 v79, 0xffff0000, v68
  v_lshlrev_b32 v80, 16, v69
  v_and_b32 v81, 0xffff0000, v69
  v_and_b32 v86, 0xffff0000, v35
  v_cmp_gt_i32 vcc, 0, v34
  v_pk_mul_f32 v[78:79], v[78:79], v[86:87] op_sel_hi:[1,0]
  v_pk_mul_f32 v[80:81], v[80:81], v[86:87] op_sel_hi:[1,0]
  v_cvt_pk_bf16_f32 v88, v78, v79
  v_cvt_pk_bf16_f32 v89, v80, v81
  s_cbranch_vccnz L_ovfbb12
L_backbb12:
  ds_write_b64 v34, v[88:89] offset:25664
L_skipb12:
  s_waitcnt vmcnt(2)
  s_mov_b64 exec, s[70:71]
  s_cbranch_execz L_skipb13
  v_lshlrev_b32 v78, 16, v70
  v_and_b32 v79, 0xffff0000, v70
  v_lshlrev_b32 v80, 16, v71
  v_and_b32 v81, 0xffff0000, v71
  v_and_b32 v86, 0xffff0000, v37
  v_cmp_gt_i32 vcc, 0, v36
  v_pk_mul_f32 v[78:79], v[78:79], v[86:87] op_sel_hi:[1,0]
  v_pk_mul_f32 v[80:81], v[80:81], v[86:87] op_sel_hi:[1,0]
  v_cvt_pk_bf16_f32 v90, v78, v79
  v_cvt_pk_bf16_f32 v91, v80, v81
  s_cbranch_vccnz L_ovfbb13
L_backbb13:
  ds_write_b64 v36, v[90:91] offset:25664
L_skipb13:
  s_waitcnt vmcnt(1)
  s_mov_b64 exec, s[72:73]
  s_cbranch_execz L_skipb14
  v_lshlrev_b32 v78, 16, v72
  v_and_b32 v79, 0xffff0000, v72
  v_lshlrev_b32 v80, 16, v73
  v_and_b32 v81, 0xffff0000, v73
  v_and_b32 v86, 0xffff0000, v39
  v_cmp_gt_i32 vcc, 0, v38
  v_pk_mul_f32 v[78:79], v[78:79], v[86:87] op_sel_hi:[1,0]
  v_pk_mul_f32 v[80:81], v[80:81], v[86:87] op_sel_hi:[1,0]
  v_cvt_pk_bf16_f32 v88, v78, v79
  v_cvt_pk_bf16_f32 v89, v80, v81
  s_cbranch_vccnz L_ovfbb14
L_backbb14:
  ds_write_b64 v38, v[88:89] offset:25664
L_skipb14:
  s_waitcnt vmcnt(0)
  s_mov_b64 exec, s[74:75]
  s_cbranch_execz L_skipb15
  v_lshlrev_b32 v78, 16, v74
  v_and_b32 v79, 0xffff0000, v74
  v_lshlrev_b32 v80, 16, v75
  v_and_b32 v81, 0xffff0000, v75
  v_and_b32 v86, 0xffff0000, v41
  v_cmp_gt_i32 vcc, 0, v40
  v_pk_mul_f32 v[78:79], v[78:79], v[86:87] op_sel_hi:[1,0]
  v_pk_mul_f32 v[80:81], v[80:81], v[86:87] op_sel_hi:[1,0]
  v_cvt_pk_bf16_f32 v90, v78, v79
  v_cvt_pk_bf16_f32 v91, v80, v81
  s_cbranch_vccnz L_ovfbb15
L_backbb15:
  ds_write_b64 v40, v[90:91] offset:25664
L_skipb15:
  s_mov_b64 exec, -1
L_left:
  v_cmp_gt_u32 vcc, v4, v5
  s_cbranch_vccz L_leftdone
  s_ff1_i32_b64 s42, vcc
  v_readlane_b32 s40, v9, s42
  v_readlane_b32 s41, v4, s42
  v_readlane_b32 s43, v5, s42
  s_add_u32 s40, s40, s43
  s_sub_u32 s41, s41, s43
  s_min_u32 s41, s41, 64
  s_add_u32 s43, s43, s41
  s_mov_b32 m0, s42
  s_nop 0
  v_writelane_b32 v5, s43, m0
  s_sub_u32 s41, 64, s41
  s_lshr_b64 exec, -1, s41
  v_add_lshl_u32 v78, s40, v1, 2
  v_add_lshl_u32 v79, s40, v1, 1
  buffer_load_dword v10, v78, s[12:15], s79 offen sc1
  buffer_load_ushort v11, v79, s[12:15], s33 offen sc1
  s_waitcnt vmcnt(0)
  v_and_b32 v78, 0x1fffff, v10
  buffer_load_dwordx2 v[44:45], v78, s[4:7], 0 offen
  s_waitcnt vmcnt(0)
  v_lshlrev_b32 v78, 16, v44
  v_and_b32 v80, 0xffff0000, v44
  v_lshlrev_b32 v82, 16, v45
  v_and_b32 v84, 0xffff0000, v45
  v_lshlrev_b32 v86, 16, v11
  v_lshrrev_b32 v87, 18, v10
  v_mul_f32 v78, v86, v78
  v_mul_f32 v80, v86, v80
  v_mul_f32 v82, v86, v82
  v_mul_f32 v84, v86, v84
  v_and_b32 v87, 0x1ff8, v87
  v_cvt_f64_f32 v[78:79], v78
  v_cvt_f64_f32 v[80:81], v80
  v_cvt_f64_f32 v[82:83], v82
  v_cvt_f64_f32 v[84:85], v84
  ds_add_f64 v87, v[78:79] offset:0
  ds_add_f64 v87, v[80:81] offset:5120
  ds_add_f64 v87, v[82:83] offset:10240
  ds_add_f64 v87, v[84:85] offset:15360
  s_mov_b64 exec, -1
  s_branch L_left
L_leftdone:
  v_lshlrev_b32 v7, 3, v0
  v_lshlrev_b32 v6, 2, v0
  v_add_u32 v76, 25664, v7
  v_add_u32 v77, 92224, v7
  v_and_b32 v90, 3, v0
  v_and_b32 v86, 1, v0
  v_lshlrev_b32 v86, 4, v86
  v_mov_b32 v87, 0x3f80
  v_lshlrev_b32 v87, v86, v87
  v_cmp_gt_u32 vcc, 2, v90
  v_mov_b32 v88, 0
  s_nop 0
  v_cndmask_b32 v86, 0, v87, vcc
  v_cndmask_b32 v87, v87, v88, vcc
  v_lshlrev_b32 v114, 16, v96
  v_and_b32 v115, 0xffff0000, v96
  v_lshlrev_b32 v116, 16, v97
  v_and_b32 v117, 0xffff0000, v97
  s_waitcnt lgkmcnt(0)
  s_barrier
  s_cmp_ge_u32 s30, 10
  s_cbranch_scc1 L_fin
  ds_read_b64 v[78:79], v7 offset:0
  ds_read_b64 v[80:81], v7 offset:5120
  ds_read_b64 v[82:83], v7 offset:10240
  ds_read_b64 v[84:85], v7 offset:15360
  s_cmp_lg_u32 s78, 0
  s_cbranch_scc1 L_norows
  ds_read_b64 v[10:11], v76 offset:0
  ds_read_b64 v[12:13], v76 offset:5120
  ds_read_b64 v[14:15], v76 offset:10240
  ds_read_b64 v[16:17], v76 offset:15360
  ds_read_b64 v[18:19], v76 offset:20480
  ds_read_b64 v[20:21], v76 offset:25600
  ds_read_b64 v[22:23], v76 offset:30720
  ds_read_b64 v[24:25], v76 offset:35840
  ds_read_b64 v[26:27], v76 offset:40960
  ds_read_b64 v[28:29], v76 offset:46080
  ds_read_b64 v[30:31], v76 offset:51200
  ds_read_b64 v[32:33], v76 offset:56320
  ds_read_b64 v[34:35], v76 offset:61440
  ds_read_b64 v[36:37], v77 offset:0
  ds_read_b64 v[38:39], v77 offset:5120
  ds_read_b64 v[40:41], v77 offset:10240
  ds_read_b64 v[42:43], v77 offset:15360
  ds_read_b64 v[44:45], v77 offset:20480
  ds_read_b64 v[46:47], v77 offset:25600
  ds_read_b64 v[48:49], v77 offset:30720
  ds_read_b64 v[50:51], v77 offset:35840
  ds_read_b64 v[52:53], v77 offset:40960
  ds_read_b64 v[54:55], v77 offset:46080
  ds_read_b64 v[56:57], v77 offset:51200
  ds_read_b64 v[58:59], v77 offset:56320
  s_mov_b64 exec, -1
  s_waitcnt lgkmcnt(12)
  v_mfma_f32_4x4x4_16b_bf16 v[60:63], v[86:87], v[10:11], 0
  v_mfma_f32_4x4x4_16b_bf16 v[64:67], v[86:87], v[12:13], 0
  v_mfma_f32_4x4x4_16b_bf16 v[68:71], v[86:87], v[14:15], 0
  v_mfma_f32_4x4x4_16b_bf16 v[72:75], v[86:87], v[16:17], 0
  v_mfma_f32_4x4x4_16b_bf16 v[60:63], v[86:87], v[18:19], v[60:63]
  v_mfma_f32_4x4x4_16b_bf16 v[64:67], v[86:87], v[20:21], v[64:67]
  v_mfma_f32_4x4x4_16b_bf16 v[68:71], v[86:87], v[22:23], v[68:71]
  v_mfma_f32_4x4x4_16b_bf16 v[72:75], v[86:87], v[24:25], v[72:75]
  v_mfma_f32_4x4x4_16b_bf16 v[60:63], v[86:87], v[26:27], v[60:63]
  v_mfma_f32_4x4x4_16b_bf16 v[64:67], v[86:87], v[28:29], v[64:67]
  v_mfma_f32_4x4x4_16b_bf16 v[68:71], v[86:87], v[30:31], v[68:71]
  v_mfma_f32_4x4x4_16b_bf16 v[72:75], v[86:87], v[32:33], v[72:75]
  s_waitcnt lgkmcnt(12)
  v_mfma_f32_4x4x4_16b_bf16 v[60:63], v[86:87], v[34:35], v[60:63]
  s_waitcnt lgkmcnt(11)
  v_mfma_f32_4x4x4_16b_bf16 v[64:67], v[86:87], v[36:37], v[64:67]
  s_waitcnt lgkmcnt(10)
  v_mfma_f32_4x4x4_16b_bf16 v[68:71], v[86:87], v[38:39], v[68:71]
  s_waitcnt lgkmcnt(9)
  v_mfma_f32_4x4x4_16b_bf16 v[72:75], v[86:87], v[40:41], v[72:75]
  s_waitcnt lgkmcnt(8)
  v_mfma_f32_4x4x4_16b_bf16 v[60:63], v[86:87], v[42:43], v[60:63]
  s_waitcnt lgkmcnt(7)
  v_mfma_f32_4x4x4_16b_bf16 v[64:67], v[86:87], v[44:45], v[64:67]
  s_waitcnt lgkmcnt(6)
  v_mfma_f32_4x4x4_16b_bf16 v[68:71], v[86:87], v[46:47], v[68:71]
  s_waitcnt lgkmcnt(5)
  v_mfma_f32_4x4x4_16b_bf16 v[72:75], v[86:87], v[48:49], v[72:75]
  s_waitcnt lgkmcnt(4)
  v_mfma_f32_4x4x4_16b_bf16 v[60:63], v[86:87], v[50:51], v[60:63]
  s_waitcnt lgkmcnt(3)
  v_mfma_f32_4x4x4_16b_bf16 v[64:67], v[86:87], v[52:53], v[64:67]
  s_waitcnt lgkmcnt(2)
  v_mfma_f32_4x4x4_16b_bf16 v[68:71], v[86:87], v[54:55], v[68:71]
  s_waitcnt lgkmcnt(1)
  v_mfma_f32_4x4x4_16b_bf16 v[72:75], v[86:87], v[56:57], v[72:75]
  s_waitcnt lgkmcnt(0)
  v_mfma_f32_4x4x4_16b_bf16 v[60:63], v[86:87], v[58:59], v[60:63]
  s_nop 4
  v_pk_add_f32 v[60:61], v[60:61], v[64:65]
  v_pk_add_f32 v[62:63], v[62:63], v[66:67]
  v_pk_add_f32 v[68:69], v[68:69], v[72:73]
  v_pk_add_f32 v[70:71], v[70:71], v[74:75]
  v_pk_add_f32 v[72:73], v[60:61], v[68:69]
  v_pk_add_f32 v[74:75], v[62:63], v[70:71]
  s_branch L_rows
L_norows:
  v_mov_b32 v72, 0
  v_mov_b32 v73, 0
  v_mov_b32 v74, 0
  v_mov_b32 v75, 0
L_rows:
  s_waitcnt lgkmcnt(0)
  v_cvt_f32_f64 v20, v[78:79]
  v_cvt_f32_f64 v21, v[80:81]
  v_cvt_f32_f64 v22, v[82:83]
  v_cvt_f32_f64 v23, v[84:85]
  v_add_f32 v20, v20, v72
  v_add_f32 v21, v21, v73
  v_add_f32 v22, v22, v74
  v_add_f32 v23, v23, v75
  v_fmac_f32 v114, v20, v98
  v_fmac_f32 v115, v20, v99
  v_fmac_f32 v116, v20, v100
  v_fmac_f32 v117, v20, v101
  v_fmac_f32 v114, v21, v102
  v_fmac_f32 v115, v21, v103
  v_fmac_f32 v116, v21, v104
  v_fmac_f32 v117, v21, v105
  v_fmac_f32 v114, v22, v106
  v_fmac_f32 v115, v22, v107
  v_fmac_f32 v116, v22, v108
  v_fmac_f32 v117, v22, v109
  v_fmac_f32 v114, v23, v110
  v_fmac_f32 v115, v23, v111
  v_fmac_f32 v116, v23, v112
  v_fmac_f32 v117, v23, v113
  v_cvt_pk_bf16_f32 v36, v114, v115
  v_cvt_pk_bf16_f32 v37, v116, v117
  buffer_store_dwordx2 v[36:37], v92, s[16:19], 0 offen
L_fin:
  s_endpgm
L_panic:
  s_mov_b32 s78, 1
  v_mov_b32 v5, 0
  v_mov_b32 v44, 0
  v_mov_b32 v46, 0
  v_mov_b32 v48, 0
  v_mov_b32 v50, 0
  v_mov_b32 v52, 0
  v_mov_b32 v54, 0
  v_mov_b32 v56, 0
  v_mov_b32 v58, 0
  v_mov_b32 v60, 0
  v_mov_b32 v62, 0
  v_mov_b32 v64, 0
  v_mov_b32 v66, 0
  v_mov_b32 v68, 0
  v_mov_b32 v70, 0
  v_mov_b32 v72, 0
  v_mov_b32 v74, 0
  s_cmp_ge_u32 s30, 10
  s_cbranch_scc1 L_left
  s_mov_b64 s[44:45], 0
  s_mov_b64 s[46:47], 0
  s_mov_b64 s[48:49], 0
  s_mov_b64 s[50:51], 0
  s_mov_b64 s[52:53], 0
  s_mov_b64 s[54:55], 0
  s_mov_b64 s[56:57], 0
  s_mov_b64 s[58:59], 0
  s_mov_b64 s[60:61], 0
  s_mov_b64 s[62:63], 0
  s_mov_b64 s[64:65], 0
  s_mov_b64 s[66:67], 0
  s_mov_b64 s[68:69], 0
  s_mov_b64 s[70:71], 0
  s_mov_b64 s[72:73], 0
  s_mov_b64 s[74:75], 0
  s_mov_b32 s30, 0
  s_branch L_pre
L_ovfba0:
  s_and_saveexec_b64 s[38:39], vcc
  v_and_b32 v87, 0x1ff8, v10
  v_cvt_f64_f32 v[84:85], v81
  v_cvt_f64_f32 v[82:83], v80
  v_cvt_f64_f32 v[80:81], v79
  v_cvt_f64_f32 v[78:79], v78
  ds_add_f64 v87, v[78:79] offset:0
  ds_add_f64 v87, v[80:81] offset:5120
  ds_add_f64 v87, v[82:83] offset:10240
  ds_add_f64 v87, v[84:85] offset:15360
  s_andn2_b64 exec, s[38:39], vcc
  s_branch L_backba0
L_ovfba1:
  s_and_saveexec_b64 s[38:39], vcc
  v_and_b32 v87, 0x1ff8, v12
  v_cvt_f64_f32 v[84:85], v81
  v_cvt_f64_f32 v[82:83], v80
  v_cvt_f64_f32 v[80:81], v79
  v_cvt_f64_f32 v[78:79], v78
  ds_add_f64 v87, v[78:79] offset:0
  ds_add_f64 v87, v[80:81] offset:5120
  ds_add_f64 v87, v[82:83] offset:10240
  ds_add_f64 v87, v[84:85] offset:15360
  s_andn2_b64 exec, s[38:39], vcc
  s_branch L_backba1
L_ovfba2:
  s_and_saveexec_b64 s[38:39], vcc
  v_and_b32 v87, 0x1ff8, v14
  v_cvt_f64_f32 v[84:85], v81
  v_cvt_f64_f32 v[82:83], v80
  v_cvt_f64_f32 v[80:81], v79
  v_cvt_f64_f32 v[78:79], v78
  ds_add_f64 v87, v[78:79] offset:0
  ds_add_f64 v87, v[80:81] offset:5120
  ds_add_f64 v87, v[82:83] offset:10240
  ds_add_f64 v87, v[84:85] offset:15360
  s_andn2_b64 exec, s[38:39], vcc
  s_branch L_backba2
L_ovfba3:
  s_and_saveexec_b64 s[38:39], vcc
  v_and_b32 v87, 0x1ff8, v16
  v_cvt_f64_f32 v[84:85], v81
  v_cvt_f64_f32 v[82:83], v80
  v_cvt_f64_f32 v[80:81], v79
  v_cvt_f64_f32 v[78:79], v78
  ds_add_f64 v87, v[78:79] offset:0
  ds_add_f64 v87, v[80:81] offset:5120
  ds_add_f64 v87, v[82:83] offset:10240
  ds_add_f64 v87, v[84:85] offset:15360
  s_andn2_b64 exec, s[38:39], vcc
  s_branch L_backba3
L_ovfba4:
  s_and_saveexec_b64 s[38:39], vcc
  v_and_b32 v87, 0x1ff8, v18
  v_cvt_f64_f32 v[84:85], v81
  v_cvt_f64_f32 v[82:83], v80
  v_cvt_f64_f32 v[80:81], v79
  v_cvt_f64_f32 v[78:79], v78
  ds_add_f64 v87, v[78:79] offset:0
  ds_add_f64 v87, v[80:81] offset:5120
  ds_add_f64 v87, v[82:83] offset:10240
  ds_add_f64 v87, v[84:85] offset:15360
  s_andn2_b64 exec, s[38:39], vcc
  s_branch L_backba4
L_ovfba5:
  s_and_saveexec_b64 s[38:39], vcc
  v_and_b32 v87, 0x1ff8, v20
  v_cvt_f64_f32 v[84:85], v81
  v_cvt_f64_f32 v[82:83], v80
  v_cvt_f64_f32 v[80:81], v79
  v_cvt_f64_f32 v[78:79], v78
  ds_add_f64 v87, v[78:79] offset:0
  ds_add_f64 v87, v[80:81] offset:5120
  ds_add_f64 v87, v[82:83] offset:10240
  ds_add_f64 v87, v[84:85] offset:15360
  s_andn2_b64 exec, s[38:39], vcc
  s_branch L_backba5
L_ovfba6:
  s_and_saveexec_b64 s[38:39], vcc
  v_and_b32 v87, 0x1ff8, v22
  v_cvt_f64_f32 v[84:85], v81
  v_cvt_f64_f32 v[82:83], v80
  v_cvt_f64_f32 v[80:81], v79
  v_cvt_f64_f32 v[78:79], v78
  ds_add_f64 v87, v[78:79] offset:0
  ds_add_f64 v87, v[80:81] offset:5120
  ds_add_f64 v87, v[82:83] offset:10240
  ds_add_f64 v87, v[84:85] offset:15360
  s_andn2_b64 exec, s[38:39], vcc
  s_branch L_backba6
L_ovfba7:
  s_and_saveexec_b64 s[38:39], vcc
  v_and_b32 v87, 0x1ff8, v24
  v_cvt_f64_f32 v[84:85], v81
  v_cvt_f64_f32 v[82:83], v80
  v_cvt_f64_f32 v[80:81], v79
  v_cvt_f64_f32 v[78:79], v78
  ds_add_f64 v87, v[78:79] offset:0
  ds_add_f64 v87, v[80:81] offset:5120
  ds_add_f64 v87, v[82:83] offset:10240
  ds_add_f64 v87, v[84:85] offset:15360
  s_andn2_b64 exec, s[38:39], vcc
  s_branch L_backba7
L_ovfba8:
  s_and_saveexec_b64 s[38:39], vcc
  v_and_b32 v87, 0x1ff8, v26
  v_cvt_f64_f32 v[84:85], v81
  v_cvt_f64_f32 v[82:83], v80
  v_cvt_f64_f32 v[80:81], v79
  v_cvt_f64_f32 v[78:79], v78
  ds_add_f64 v87, v[78:79] offset:0
  ds_add_f64 v87, v[80:81] offset:5120
  ds_add_f64 v87, v[82:83] offset:10240
  ds_add_f64 v87, v[84:85] offset:15360
  s_andn2_b64 exec, s[38:39], vcc
  s_branch L_backba8
L_ovfba9:
  s_and_saveexec_b64 s[38:39], vcc
  v_and_b32 v87, 0x1ff8, v28
  v_cvt_f64_f32 v[84:85], v81
  v_cvt_f64_f32 v[82:83], v80
  v_cvt_f64_f32 v[80:81], v79
  v_cvt_f64_f32 v[78:79], v78
  ds_add_f64 v87, v[78:79] offset:0
  ds_add_f64 v87, v[80:81] offset:5120
  ds_add_f64 v87, v[82:83] offset:10240
  ds_add_f64 v87, v[84:85] offset:15360
  s_andn2_b64 exec, s[38:39], vcc
  s_branch L_backba9
L_ovfba10:
  s_and_saveexec_b64 s[38:39], vcc
  v_and_b32 v87, 0x1ff8, v30
  v_cvt_f64_f32 v[84:85], v81
  v_cvt_f64_f32 v[82:83], v80
  v_cvt_f64_f32 v[80:81], v79
  v_cvt_f64_f32 v[78:79], v78
  ds_add_f64 v87, v[78:79] offset:0
  ds_add_f64 v87, v[80:81] offset:5120
  ds_add_f64 v87, v[82:83] offset:10240
  ds_add_f64 v87, v[84:85] offset:15360
  s_andn2_b64 exec, s[38:39], vcc
  s_branch L_backba10
L_ovfba11:
  s_and_saveexec_b64 s[38:39], vcc
  v_and_b32 v87, 0x1ff8, v32
  v_cvt_f64_f32 v[84:85], v81
  v_cvt_f64_f32 v[82:83], v80
  v_cvt_f64_f32 v[80:81], v79
  v_cvt_f64_f32 v[78:79], v78
  ds_add_f64 v87, v[78:79] offset:0
  ds_add_f64 v87, v[80:81] offset:5120
  ds_add_f64 v87, v[82:83] offset:10240
  ds_add_f64 v87, v[84:85] offset:15360
  s_andn2_b64 exec, s[38:39], vcc
  s_branch L_backba11
L_ovfba12:
  s_and_saveexec_b64 s[38:39], vcc
  v_and_b32 v87, 0x1ff8, v34
  v_cvt_f64_f32 v[84:85], v81
  v_cvt_f64_f32 v[82:83], v80
  v_cvt_f64_f32 v[80:81], v79
  v_cvt_f64_f32 v[78:79], v78
  ds_add_f64 v87, v[78:79] offset:0
  ds_add_f64 v87, v[80:81] offset:5120
  ds_add_f64 v87, v[82:83] offset:10240
  ds_add_f64 v87, v[84:85] offset:15360
  s_andn2_b64 exec, s[38:39], vcc
  s_branch L_backba12
L_ovfba13:
  s_and_saveexec_b64 s[38:39], vcc
  v_and_b32 v87, 0x1ff8, v36
  v_cvt_f64_f32 v[84:85], v81
  v_cvt_f64_f32 v[82:83], v80
  v_cvt_f64_f32 v[80:81], v79
  v_cvt_f64_f32 v[78:79], v78
  ds_add_f64 v87, v[78:79] offset:0
  ds_add_f64 v87, v[80:81] offset:5120
  ds_add_f64 v87, v[82:83] offset:10240
  ds_add_f64 v87, v[84:85] offset:15360
  s_andn2_b64 exec, s[38:39], vcc
  s_branch L_backba13
L_ovfba14:
  s_and_saveexec_b64 s[38:39], vcc
  v_and_b32 v87, 0x1ff8, v38
  v_cvt_f64_f32 v[84:85], v81
  v_cvt_f64_f32 v[82:83], v80
  v_cvt_f64_f32 v[80:81], v79
  v_cvt_f64_f32 v[78:79], v78
  ds_add_f64 v87, v[78:79] offset:0
  ds_add_f64 v87, v[80:81] offset:5120
  ds_add_f64 v87, v[82:83] offset:10240
  ds_add_f64 v87, v[84:85] offset:15360
  s_andn2_b64 exec, s[38:39], vcc
  s_branch L_backba14
L_ovfba15:
  s_and_saveexec_b64 s[38:39], vcc
  v_and_b32 v87, 0x1ff8, v40
  v_cvt_f64_f32 v[84:85], v81
  v_cvt_f64_f32 v[82:83], v80
  v_cvt_f64_f32 v[80:81], v79
  v_cvt_f64_f32 v[78:79], v78
  ds_add_f64 v87, v[78:79] offset:0
  ds_add_f64 v87, v[80:81] offset:5120
  ds_add_f64 v87, v[82:83] offset:10240
  ds_add_f64 v87, v[84:85] offset:15360
  s_andn2_b64 exec, s[38:39], vcc
  s_branch L_backba15
L_ovfbb0:
  s_and_saveexec_b64 s[38:39], vcc
  v_and_b32 v87, 0x1ff8, v10
  v_cvt_f64_f32 v[84:85], v81
  v_cvt_f64_f32 v[82:83], v80
  v_cvt_f64_f32 v[80:81], v79
  v_cvt_f64_f32 v[78:79], v78
  ds_add_f64 v87, v[78:79] offset:0
  ds_add_f64 v87, v[80:81] offset:5120
  ds_add_f64 v87, v[82:83] offset:10240
  ds_add_f64 v87, v[84:85] offset:15360
  s_andn2_b64 exec, s[38:39], vcc
  s_branch L_backbb0
L_ovfbb1:
  s_and_saveexec_b64 s[38:39], vcc
  v_and_b32 v87, 0x1ff8, v12
  v_cvt_f64_f32 v[84:85], v81
  v_cvt_f64_f32 v[82:83], v80
  v_cvt_f64_f32 v[80:81], v79
  v_cvt_f64_f32 v[78:79], v78
  ds_add_f64 v87, v[78:79] offset:0
  ds_add_f64 v87, v[80:81] offset:5120
  ds_add_f64 v87, v[82:83] offset:10240
  ds_add_f64 v87, v[84:85] offset:15360
  s_andn2_b64 exec, s[38:39], vcc
  s_branch L_backbb1
L_ovfbb2:
  s_and_saveexec_b64 s[38:39], vcc
  v_and_b32 v87, 0x1ff8, v14
  v_cvt_f64_f32 v[84:85], v81
  v_cvt_f64_f32 v[82:83], v80
  v_cvt_f64_f32 v[80:81], v79
  v_cvt_f64_f32 v[78:79], v78
  ds_add_f64 v87, v[78:79] offset:0
  ds_add_f64 v87, v[80:81] offset:5120
  ds_add_f64 v87, v[82:83] offset:10240
  ds_add_f64 v87, v[84:85] offset:15360
  s_andn2_b64 exec, s[38:39], vcc
  s_branch L_backbb2
L_ovfbb3:
  s_and_saveexec_b64 s[38:39], vcc
  v_and_b32 v87, 0x1ff8, v16
  v_cvt_f64_f32 v[84:85], v81
  v_cvt_f64_f32 v[82:83], v80
  v_cvt_f64_f32 v[80:81], v79
  v_cvt_f64_f32 v[78:79], v78
  ds_add_f64 v87, v[78:79] offset:0
  ds_add_f64 v87, v[80:81] offset:5120
  ds_add_f64 v87, v[82:83] offset:10240
  ds_add_f64 v87, v[84:85] offset:15360
  s_andn2_b64 exec, s[38:39], vcc
  s_branch L_backbb3
L_ovfbb4:
  s_and_saveexec_b64 s[38:39], vcc
  v_and_b32 v87, 0x1ff8, v18
  v_cvt_f64_f32 v[84:85], v81
  v_cvt_f64_f32 v[82:83], v80
  v_cvt_f64_f32 v[80:81], v79
  v_cvt_f64_f32 v[78:79], v78
  ds_add_f64 v87, v[78:79] offset:0
  ds_add_f64 v87, v[80:81] offset:5120
  ds_add_f64 v87, v[82:83] offset:10240
  ds_add_f64 v87, v[84:85] offset:15360
  s_andn2_b64 exec, s[38:39], vcc
  s_branch L_backbb4
L_ovfbb5:
  s_and_saveexec_b64 s[38:39], vcc
  v_and_b32 v87, 0x1ff8, v20
  v_cvt_f64_f32 v[84:85], v81
  v_cvt_f64_f32 v[82:83], v80
  v_cvt_f64_f32 v[80:81], v79
  v_cvt_f64_f32 v[78:79], v78
  ds_add_f64 v87, v[78:79] offset:0
  ds_add_f64 v87, v[80:81] offset:5120
  ds_add_f64 v87, v[82:83] offset:10240
  ds_add_f64 v87, v[84:85] offset:15360
  s_andn2_b64 exec, s[38:39], vcc
  s_branch L_backbb5
L_ovfbb6:
  s_and_saveexec_b64 s[38:39], vcc
  v_and_b32 v87, 0x1ff8, v22
  v_cvt_f64_f32 v[84:85], v81
  v_cvt_f64_f32 v[82:83], v80
  v_cvt_f64_f32 v[80:81], v79
  v_cvt_f64_f32 v[78:79], v78
  ds_add_f64 v87, v[78:79] offset:0
  ds_add_f64 v87, v[80:81] offset:5120
  ds_add_f64 v87, v[82:83] offset:10240
  ds_add_f64 v87, v[84:85] offset:15360
  s_andn2_b64 exec, s[38:39], vcc
  s_branch L_backbb6
L_ovfbb7:
  s_and_saveexec_b64 s[38:39], vcc
  v_and_b32 v87, 0x1ff8, v24
  v_cvt_f64_f32 v[84:85], v81
  v_cvt_f64_f32 v[82:83], v80
  v_cvt_f64_f32 v[80:81], v79
  v_cvt_f64_f32 v[78:79], v78
  ds_add_f64 v87, v[78:79] offset:0
  ds_add_f64 v87, v[80:81] offset:5120
  ds_add_f64 v87, v[82:83] offset:10240
  ds_add_f64 v87, v[84:85] offset:15360
  s_andn2_b64 exec, s[38:39], vcc
  s_branch L_backbb7
L_ovfbb8:
  s_and_saveexec_b64 s[38:39], vcc
  v_and_b32 v87, 0x1ff8, v26
  v_cvt_f64_f32 v[84:85], v81
  v_cvt_f64_f32 v[82:83], v80
  v_cvt_f64_f32 v[80:81], v79
  v_cvt_f64_f32 v[78:79], v78
  ds_add_f64 v87, v[78:79] offset:0
  ds_add_f64 v87, v[80:81] offset:5120
  ds_add_f64 v87, v[82:83] offset:10240
  ds_add_f64 v87, v[84:85] offset:15360
  s_andn2_b64 exec, s[38:39], vcc
  s_branch L_backbb8
L_ovfbb9:
  s_and_saveexec_b64 s[38:39], vcc
  v_and_b32 v87, 0x1ff8, v28
  v_cvt_f64_f32 v[84:85], v81
  v_cvt_f64_f32 v[82:83], v80
  v_cvt_f64_f32 v[80:81], v79
  v_cvt_f64_f32 v[78:79], v78
  ds_add_f64 v87, v[78:79] offset:0
  ds_add_f64 v87, v[80:81] offset:5120
  ds_add_f64 v87, v[82:83] offset:10240
  ds_add_f64 v87, v[84:85] offset:15360
  s_andn2_b64 exec, s[38:39], vcc
  s_branch L_backbb9
L_ovfbb10:
  s_and_saveexec_b64 s[38:39], vcc
  v_and_b32 v87, 0x1ff8, v30
  v_cvt_f64_f32 v[84:85], v81
  v_cvt_f64_f32 v[82:83], v80
  v_cvt_f64_f32 v[80:81], v79
  v_cvt_f64_f32 v[78:79], v78
  ds_add_f64 v87, v[78:79] offset:0
  ds_add_f64 v87, v[80:81] offset:5120
  ds_add_f64 v87, v[82:83] offset:10240
  ds_add_f64 v87, v[84:85] offset:15360
  s_andn2_b64 exec, s[38:39], vcc
  s_branch L_backbb10
L_ovfbb11:
  s_and_saveexec_b64 s[38:39], vcc
  v_and_b32 v87, 0x1ff8, v32
  v_cvt_f64_f32 v[84:85], v81
  v_cvt_f64_f32 v[82:83], v80
  v_cvt_f64_f32 v[80:81], v79
  v_cvt_f64_f32 v[78:79], v78
  ds_add_f64 v87, v[78:79] offset:0
  ds_add_f64 v87, v[80:81] offset:5120
  ds_add_f64 v87, v[82:83] offset:10240
  ds_add_f64 v87, v[84:85] offset:15360
  s_andn2_b64 exec, s[38:39], vcc
  s_branch L_backbb11
L_ovfbb12:
  s_and_saveexec_b64 s[38:39], vcc
  v_and_b32 v87, 0x1ff8, v34
  v_cvt_f64_f32 v[84:85], v81
  v_cvt_f64_f32 v[82:83], v80
  v_cvt_f64_f32 v[80:81], v79
  v_cvt_f64_f32 v[78:79], v78
  ds_add_f64 v87, v[78:79] offset:0
  ds_add_f64 v87, v[80:81] offset:5120
  ds_add_f64 v87, v[82:83] offset:10240
  ds_add_f64 v87, v[84:85] offset:15360
  s_andn2_b64 exec, s[38:39], vcc
  s_branch L_backbb12
L_ovfbb13:
  s_and_saveexec_b64 s[38:39], vcc
  v_and_b32 v87, 0x1ff8, v36
  v_cvt_f64_f32 v[84:85], v81
  v_cvt_f64_f32 v[82:83], v80
  v_cvt_f64_f32 v[80:81], v79
  v_cvt_f64_f32 v[78:79], v78
  ds_add_f64 v87, v[78:79] offset:0
  ds_add_f64 v87, v[80:81] offset:5120
  ds_add_f64 v87, v[82:83] offset:10240
  ds_add_f64 v87, v[84:85] offset:15360
  s_andn2_b64 exec, s[38:39], vcc
  s_branch L_backbb13
L_ovfbb14:
  s_and_saveexec_b64 s[38:39], vcc
  v_and_b32 v87, 0x1ff8, v38
  v_cvt_f64_f32 v[84:85], v81
  v_cvt_f64_f32 v[82:83], v80
  v_cvt_f64_f32 v[80:81], v79
  v_cvt_f64_f32 v[78:79], v78
  ds_add_f64 v87, v[78:79] offset:0
  ds_add_f64 v87, v[80:81] offset:5120
  ds_add_f64 v87, v[82:83] offset:10240
  ds_add_f64 v87, v[84:85] offset:15360
  s_andn2_b64 exec, s[38:39], vcc
  s_branch L_backbb14
L_ovfbb15:
  s_and_saveexec_b64 s[38:39], vcc
  v_and_b32 v87, 0x1ff8, v40
  v_cvt_f64_f32 v[84:85], v81
  v_cvt_f64_f32 v[82:83], v80
  v_cvt_f64_f32 v[80:81], v79
  v_cvt_f64_f32 v[78:79], v78
  ds_add_f64 v87, v[78:79] offset:0
  ds_add_f64 v87, v[80:81] offset:5120
  ds_add_f64 v87, v[82:83] offset:10240
  ds_add_f64 v87, v[84:85] offset:15360
  s_andn2_b64 exec, s[38:39], vcc
  s_branch L_backbb15
L_ovf0:
  s_and_saveexec_b64 s[38:39], vcc
  v_mov_b32 v62, 0
  ds_add_rtn_u32 v53, v62, v8 offset:25600
  s_waitcnt lgkmcnt(0)
  v_lshlrev_b32 v44, 3, v53
  v_add_u32 v44, 130000, v44
  v_cmp_le_u32 vcc, 134, v53
  s_cbranch_vccz L_ovfok0
  s_and_b64 exec, exec, vcc
  v_mov_b32 v44, 131072
  ds_write_b32 v62, v8 offset:25604
L_ovfok0:
  s_mov_b64 exec, s[38:39]
  s_branch L_back0
L_ovf1:
  s_and_saveexec_b64 s[38:39], vcc
  v_mov_b32 v62, 0
  ds_add_rtn_u32 v54, v62, v8 offset:25600
  s_waitcnt lgkmcnt(0)
  v_lshlrev_b32 v45, 3, v54
  v_add_u32 v45, 130000, v45
  v_cmp_le_u32 vcc, 134, v54
  s_cbranch_vccz L_ovfok1
  s_and_b64 exec, exec, vcc
  v_mov_b32 v45, 131072
  ds_write_b32 v62, v8 offset:25604
L_ovfok1:
  s_mov_b64 exec, s[38:39]
  s_branch L_back1
L_ovf2:
  s_and_saveexec_b64 s[38:39], vcc
  v_mov_b32 v62, 0
  ds_add_rtn_u32 v55, v62, v8 offset:25600
  s_waitcnt lgkmcnt(0)
  v_lshlrev_b32 v46, 3, v55
  v_add_u32 v46, 130000, v46
  v_cmp_le_u32 vcc, 134, v55
  s_cbranch_vccz L_ovfok2
  s_and_b64 exec, exec, vcc
  v_mov_b32 v46, 131072
  ds_write_b32 v62, v8 offset:25604
L_ovfok2:
  s_mov_b64 exec, s[38:39]
  s_branch L_back2
L_ovf3:
  s_and_saveexec_b64 s[38:39], vcc
  v_mov_b32 v62, 0
  ds_add_rtn_u32 v56, v62, v8 offset:25600
  s_waitcnt lgkmcnt(0)
  v_lshlrev_b32 v47, 3, v56
  v_add_u32 v47, 130000, v47
  v_cmp_le_u32 vcc, 134, v56
  s_cbranch_vccz L_ovfok3
  s_and_b64 exec, exec, vcc
  v_mov_b32 v47, 131072
  ds_write_b32 v62, v8 offset:25604
L_ovfok3:
  s_mov_b64 exec, s[38:39]
  s_branch L_back3
L_ovf4:
  s_and_saveexec_b64 s[38:39], vcc
  v_mov_b32 v62, 0
  ds_add_rtn_u32 v53, v62, v8 offset:25600
  s_waitcnt lgkmcnt(0)
  v_lshlrev_b32 v44, 3, v53
  v_add_u32 v44, 130000, v44
  v_cmp_le_u32 vcc, 134, v53
  s_cbranch_vccz L_ovfok4
  s_and_b64 exec, exec, vcc
  v_mov_b32 v44, 131072
  ds_write_b32 v62, v8 offset:25604
L_ovfok4:
  s_mov_b64 exec, s[38:39]
  s_branch L_back4
L_ovf5:
  s_and_saveexec_b64 s[38:39], vcc
  v_mov_b32 v62, 0
  ds_add_rtn_u32 v54, v62, v8 offset:25600
  s_waitcnt lgkmcnt(0)
  v_lshlrev_b32 v45, 3, v54
  v_add_u32 v45, 130000, v45
  v_cmp_le_u32 vcc, 134, v54
  s_cbranch_vccz L_ovfok5
  s_and_b64 exec, exec, vcc
  v_mov_b32 v45, 131072
  ds_write_b32 v62, v8 offset:25604
L_ovfok5:
  s_mov_b64 exec, s[38:39]
  s_branch L_back5
L_ovf6:
  s_and_saveexec_b64 s[38:39], vcc
  v_mov_b32 v62, 0
  ds_add_rtn_u32 v55, v62, v8 offset:25600
  s_waitcnt lgkmcnt(0)
  v_lshlrev_b32 v46, 3, v55
  v_add_u32 v46, 130000, v46
  v_cmp_le_u32 vcc, 134, v55
  s_cbranch_vccz L_ovfok6
  s_and_b64 exec, exec, vcc
  v_mov_b32 v46, 131072
  ds_write_b32 v62, v8 offset:25604
L_ovfok6:
  s_mov_b64 exec, s[38:39]
  s_branch L_back6
L_ovf7:
  s_and_saveexec_b64 s[38:39], vcc
  v_mov_b32 v62, 0
  ds_add_rtn_u32 v56, v62, v8 offset:25600
  s_waitcnt lgkmcnt(0)
  v_lshlrev_b32 v47, 3, v56
  v_add_u32 v47, 130000, v47
  v_cmp_le_u32 vcc, 134, v56
  s_cbranch_vccz L_ovfok7
  s_and_b64 exec, exec, vcc
  v_mov_b32 v47, 131072
  ds_write_b32 v62, v8 offset:25604
L_ovfok7:
  s_mov_b64 exec, s[38:39]
  s_branch L_back7
L_ovf8:
  s_and_saveexec_b64 s[38:39], vcc
  v_mov_b32 v62, 0
  ds_add_rtn_u32 v53, v62, v8 offset:25600
  s_waitcnt lgkmcnt(0)
  v_lshlrev_b32 v44, 3, v53
  v_add_u32 v44, 130000, v44
  v_cmp_le_u32 vcc, 134, v53
  s_cbranch_vccz L_ovfok8
  s_and_b64 exec, exec, vcc
  v_mov_b32 v44, 131072
  ds_write_b32 v62, v8 offset:25604
L_ovfok8:
  s_mov_b64 exec, s[38:39]
  s_branch L_back8
L_ovf9:
  s_and_saveexec_b64 s[38:39], vcc
  v_mov_b32 v62, 0
  ds_add_rtn_u32 v54, v62, v8 offset:25600
  s_waitcnt lgkmcnt(0)
  v_lshlrev_b32 v45, 3, v54
  v_add_u32 v45, 130000, v45
  v_cmp_le_u32 vcc, 134, v54
  s_cbranch_vccz L_ovfok9
  s_and_b64 exec, exec, vcc
  v_mov_b32 v45, 131072
  ds_write_b32 v62, v8 offset:25604
L_ovfok9:
  s_mov_b64 exec, s[38:39]
  s_branch L_back9
L_ovf10:
  s_and_saveexec_b64 s[38:39], vcc
  v_mov_b32 v62, 0
  ds_add_rtn_u32 v55, v62, v8 offset:25600
  s_waitcnt lgkmcnt(0)
  v_lshlrev_b32 v46, 3, v55
  v_add_u32 v46, 130000, v46
  v_cmp_le_u32 vcc, 134, v55
  s_cbranch_vccz L_ovfok10
  s_and_b64 exec, exec, vcc
  v_mov_b32 v46, 131072
  ds_write_b32 v62, v8 offset:25604
L_ovfok10:
  s_mov_b64 exec, s[38:39]
  s_branch L_back10
L_ovf11:
  s_and_saveexec_b64 s[38:39], vcc
  v_mov_b32 v62, 0
  ds_add_rtn_u32 v56, v62, v8 offset:25600
  s_waitcnt lgkmcnt(0)
  v_lshlrev_b32 v47, 3, v56
  v_add_u32 v47, 130000, v47
  v_cmp_le_u32 vcc, 134, v56
  s_cbranch_vccz L_ovfok11
  s_and_b64 exec, exec, vcc
  v_mov_b32 v47, 131072
  ds_write_b32 v62, v8 offset:25604
L_ovfok11:
  s_mov_b64 exec, s[38:39]
  s_branch L_back11
L_ovf12:
  s_and_saveexec_b64 s[38:39], vcc
  v_mov_b32 v62, 0
  ds_add_rtn_u32 v53, v62, v8 offset:25600
  s_waitcnt lgkmcnt(0)
  v_lshlrev_b32 v44, 3, v53
  v_add_u32 v44, 130000, v44
  v_cmp_le_u32 vcc, 134, v53
  s_cbranch_vccz L_ovfok12
  s_and_b64 exec, exec, vcc
  v_mov_b32 v44, 131072
  ds_write_b32 v62, v8 offset:25604
L_ovfok12:
  s_mov_b64 exec, s[38:39]
  s_branch L_back12
L_ovf13:
  s_and_saveexec_b64 s[38:39], vcc
  v_mov_b32 v62, 0
  ds_add_rtn_u32 v54, v62, v8 offset:25600
  s_waitcnt lgkmcnt(0)
  v_lshlrev_b32 v45, 3, v54
  v_add_u32 v45, 130000, v45
  v_cmp_le_u32 vcc, 134, v54
  s_cbranch_vccz L_ovfok13
  s_and_b64 exec, exec, vcc
  v_mov_b32 v45, 131072
  ds_write_b32 v62, v8 offset:25604
L_ovfok13:
  s_mov_b64 exec, s[38:39]
  s_branch L_back13
L_ovf14:
  s_and_saveexec_b64 s[38:39], vcc
  v_mov_b32 v62, 0
  ds_add_rtn_u32 v55, v62, v8 offset:25600
  s_waitcnt lgkmcnt(0)
  v_lshlrev_b32 v46, 3, v55
  v_add_u32 v46, 130000, v46
  v_cmp_le_u32 vcc, 134, v55
  s_cbranch_vccz L_ovfok14
  s_and_b64 exec, exec, vcc
  v_mov_b32 v46, 131072
  ds_write_b32 v62, v8 offset:25604
L_ovfok14:
  s_mov_b64 exec, s[38:39]
  s_branch L_back14
L_ovf15:
  s_and_saveexec_b64 s[38:39], vcc
  v_mov_b32 v62, 0
  ds_add_rtn_u32 v56, v62, v8 offset:25600
  s_waitcnt lgkmcnt(0)
  v_lshlrev_b32 v47, 3, v56
  v_add_u32 v47, 130000, v47
  v_cmp_le_u32 vcc, 134, v56
  s_cbranch_vccz L_ovfok15
  s_and_b64 exec, exec, vcc
  v_mov_b32 v47, 131072
  ds_write_b32 v62, v8 offset:25604
L_ovfok15:
  s_mov_b64 exec, s[38:39]
  s_branch L_back15
L_ovf16:
  s_and_saveexec_b64 s[38:39], vcc
  v_mov_b32 v62, 0
  ds_add_rtn_u32 v57, v62, v8 offset:25600
  s_waitcnt lgkmcnt(0)
  v_lshlrev_b32 v48, 3, v57
  v_add_u32 v48, 130000, v48
  v_cmp_le_u32 vcc, 134, v57
  s_cbranch_vccz L_ovfok16
  s_and_b64 exec, exec, vcc
  v_mov_b32 v48, 131072
  ds_write_b32 v62, v8 offset:25604
L_ovfok16:
  s_mov_b64 exec, s[38:39]
  s_branch L_back16
L_end:
  s_endpgm
.section .rodata,"a"
.p2align 6
.amdhsa_kernel gather_scatter__molecular_angular_gemnet__graph_kernel
  .amdhsa_next_free_vgpr 120
  .amdhsa_next_free_sgpr 102
  .amdhsa_accum_offset 120
  .amdhsa_group_segment_fixed_size 0
  .amdhsa_kernarg_size 112
  .amdhsa_user_sgpr_count 2
  .amdhsa_user_sgpr_kernarg_segment_ptr 1
  .amdhsa_system_sgpr_workgroup_id_x 1
  .amdhsa_float_denorm_mode_32 3
.end_amdhsa_kernel
```
